```python
import torch

def _softmax(x, axis=-1):
    return torch.softmax(x, dim=axis)
def _gelu(x):
    return torch.nn.functional.gelu(x, approximate="tanh")
def _silu(x):
    return torch.nn.functional.silu(x)
def _sigmoid(x):
    return torch.sigmoid(x)
def _layernorm(x, axis=-1, eps=1e-5):
    m = x.mean(dim=axis, keepdim=True)
    v = x.var(dim=axis, keepdim=True, unbiased=False)
    return (x - m) / torch.sqrt(v + eps)
def _scatter_add(tgt, idx, src, axis=0):
    return tgt.clone().index_add_(axis, idx, src)
def _segment_sum(src, seg, n):
    out = torch.zeros((n,) + src.shape[1:], dtype=src.dtype)
    return out.index_add_(0, seg, src)
def _pad(x, pw):
    flat = tuple(v for pair in reversed(pw) for v in pair)
    return torch.nn.functional.pad(x, flat)

kernel_name = 'standalone__mha_softmax__near_ridge'

def setup_inputs():

    _w = (lambda a: (lambda t: t.to(torch.bfloat16) if t.is_floating_point() else t)(torch.as_tensor(a)))
    B, H, Sq, Sk, D = 8, 32, 256, 2048, 128
    return {
        "q": _w((lambda *s: torch.randn(*s, dtype=torch.bfloat16) * 0.8)(B, H, Sq, D)),
        "k": _w((lambda *s: torch.randn(*s, dtype=torch.bfloat16) * 0.8)(B, H, Sk, D)),
        "v": _w((lambda *s: torch.randn(*s, dtype=torch.bfloat16) * 0.05)(B, H, Sk, D)),
    }

def reference(q, k, v):
    scale = q.shape[-1] ** -0.5
    scores = torch.einsum("bhqd,bhkd->bhqk", q, k) * scale
    p = _softmax(scores, axis=-1)
    return torch.einsum("bhqk,bhkd->bhqd", p, v)
```

```asm
; @launch grid=(256,1,1) block=(256,1,1) lds=131072
.amdgcn_target "amdgcn-amd-amdhsa--gfx950"
.text
.globl standalone__mha_softmax__near_ridge_kernel
.p2align 8
.type standalone__mha_softmax__near_ridge_kernel,@function
standalone__mha_softmax__near_ridge_kernel:
    s_cmp_ge_u32 s2, 256
    s_cbranch_scc1 L_end
    s_load_dwordx4 s[4:7], s[0:1], 0
    s_load_dwordx4 s[8:11], s[0:1], 16
    v_lshrrev_b32 v1, 6, v0
    v_and_b32 v25, 63, v0
    v_readfirstlane_b32 s3, v1
    v_lshrrev_b32 v2, 4, v25
    v_and_b32 v3, 15, v25
    v_xor_b32 v4, v3, v2
    v_lshlrev_b32 v4, 4, v4
    v_lshl_add_u32 v12, v2, 8, v4
    v_lshrrev_b32 v6, 1, v1
    v_lshlrev_b32 v6, 8, v6
    v_and_b32 v7, 1, v2
    v_lshl_add_u32 v30, v7, 15, v6
    v_xor_b32 v12, v12, v30
    v_xor_b32 v13, 64, v12
    v_xor_b32 v14, 128, v12
    v_xor_b32 v15, 192, v12
    s_lshl_b32 s36, s3, 11
    s_and_b32 s12, s3, 1
    s_lshl_b32 s12, s12, 7
    v_xor_b32 v6, v2, v1
    v_lshlrev_b32 v6, 8, v6
    v_lshl_add_u32 v6, v2, 15, v6
    v_add_u32 v28, v4, v6
    v_xor_b32 v26, s12, v28
    v_xor_b32 v27, 64, v26
    s_mul_i32 s46, s2, 0x9E3779B1
    s_lshr_b32 s46, s46, 11
    s_and_b32 s46, s46, 0x67800
    s_xor_b32 s42, s46, 0x0
    s_xor_b32 s44, s42, 0x800
    s_lshl_b32 s12, s2, 16
    s_lshl_b32 s13, s2, 19
    s_lshl_b32 s37, s3, 14
    s_and_b32 s37, s37, 0x4000
    s_add_u32 s40, s36, 0x8000
    s_add_u32 s41, s36, 98304
    s_mov_b32 s22, 524288
    s_mov_b32 s23, 0x20000
    s_mov_b32 s18, 65536
    s_mov_b32 s19, 0x20000
    s_add_u32 m0, s40, 16384
    s_waitcnt lgkmcnt(0)
    s_add_u32 s20, s6, s13
    s_addc_u32 s21, s7, 0
    buffer_load_dwordx4 v26, s[20:23], s42 offen nt lds
    buffer_load_dwordx4 v27, s[20:23], s42 offen offset:1024 nt lds
    s_add_u32 m0, s40, 24576
    s_nop 0
    buffer_load_dwordx4 v26, s[20:23], s44 offen nt lds
    buffer_load_dwordx4 v27, s[20:23], s44 offen offset:1024 nt lds
    s_add_u32 s16, s4, s12
    s_addc_u32 s17, s5, 0
    s_add_u32 m0, s36, 16384
    s_xor_b32 s38, s37, 0
    buffer_load_dwordx4 v12, s[16:19], s38 offen nt lds
    buffer_load_dwordx4 v13, s[16:19], s38 offen offset:1024 nt lds
    s_add_u32 m0, s36, 24576
    s_xor_b32 s38, s37, 2048
    buffer_load_dwordx4 v14, s[16:19], s38 offen nt lds
    buffer_load_dwordx4 v15, s[16:19], s38 offen offset:1024 nt lds
    s_add_u32 m0, s36, 32768
    s_xor_b32 s38, s37, 4096
    buffer_load_dwordx4 v12, s[16:19], s38 offen nt lds
    buffer_load_dwordx4 v13, s[16:19], s38 offen offset:1024 nt lds
    s_add_u32 m0, s36, 40960
    s_xor_b32 s38, s37, 6144
    buffer_load_dwordx4 v14, s[16:19], s38 offen nt lds
    buffer_load_dwordx4 v15, s[16:19], s38 offen offset:1024 nt lds
    s_add_u32 s24, s8, s13
    s_addc_u32 s25, s9, 0
    s_add_u32 s28, s10, s12
    s_addc_u32 s29, s11, 0
    s_getpc_b64 s[14:15]
L_pc:
    s_lshr_b32 s12, s2, 3
    s_lshl_b32 s12, s12, 2
    s_add_u32 s12, s12, s3
    s_lshl_b32 s12, s12, 6
    s_min_u32 s13, s12, L_tail-L_mid
    s_add_u32 s13, s13, L_mid-L_pc
    s_load_dword s60, s[14:15], s13
    s_min_u32 s13, s12, L_end-L_tail
    s_add_u32 s13, s13, L_tail-L_pc
    s_load_dword s61, s[14:15], s13
    s_mov_b32 s26, 524288
    s_mov_b32 s27, 0x20000
    s_mov_b32 s30, 65536
    s_mov_b32 s31, 0x20000
    s_or_b32 s46, s46, 0x18000
    s_mov_b32 s33, 0x18000
    s_add_u32 s33, s33, 0x1000
    s_or_b32 s33, s33, 0x18000
    s_xor_b32 s43, s33, s46
    s_xor_b32 s45, s43, 0x800
    v_xor_b32 v29, 0x80, v28
    v_lshl_add_u32 v32, v3, 8, v4
    v_xor_b32 v33, 64, v32
    v_xor_b32 v34, 128, v32
    v_xor_b32 v35, 192, v32
    v_lshrrev_b32 v5, 3, v3
    v_mul_u32_u24 v5, 6144, v5
    v_add_u32 v5, s36, v5
    v_add_u32 v92, v32, v5
    v_add_u32 v93, v33, v5
    v_add_u32 v94, v34, v5
    v_add_u32 v95, v35, v5
    s_mov_b32 s34, 0x3e0293ee
    s_mov_b32 s35, 0x3e0293ee
    v_lshrrev_b32 v5, 2, v25
    v_and_b32 v6, 3, v5
    v_bfe_u32 v7, v25, 4, 1
    v_lshl_add_u32 v6, v7, 3, v6
    v_and_b32 v7, 3, v25
    v_lshlrev_b32 v8, 2, v7
    v_xor_b32 v6, v6, v8
    v_lshlrev_b32 v6, 4, v6
    v_lshl_add_u32 v6, v5, 8, v6
    v_lshrrev_b32 v8, 1, v7
    v_lshl_add_u32 v6, v8, 3, v6
    v_add_u32 v36, 65536, v6
    v_xor_b32 v37, 16, v36
    v_xor_b32 v38, 32, v36
    v_xor_b32 v39, 48, v36
    v_xor_b32 v40, 8, v36
    v_xor_b32 v41, 24, v36
    v_xor_b32 v42, 40, v36
    v_xor_b32 v43, 56, v36
    v_and_b32 v5, 2, v25
    v_cmp_eq_u32 vcc, 0, v5
    v_mov_b32 v6, 0x3f803f80
    v_and_b32 v5, 1, v25
    v_cndmask_b32 v20, 0, v6, vcc
    v_cndmask_b32 v21, 0, v6, vcc
    v_cndmask_b32 v22, 0, v6, vcc
    v_cndmask_b32 v23, 0, v6, vcc
    v_cmp_eq_u32 vcc, 0, v5
    v_mov_b32 v6, 0x44444444
    v_mov_b32 v7, 0xeeeeeeee
    v_cndmask_b32 v24, v7, v6, vcc
    v_lshlrev_b32 v5, 4, v25
    v_xor_b32 v30, v30, v5
    v_add_u32 v30, s37, v30
    v_add_u32 v16, s36, v5
    v_xor_b32 v17, 0x80, v16
    v_and_b32 v5, 3, v25
    v_bfe_u32 v6, v25, 2, 2
    v_lshl_add_u32 v6, v5, 2, v6
    v_bfe_u32 v7, v25, 4, 1
    v_lshlrev_b32 v8, 3, v7
    v_xor_b32 v6, v6, v8
    v_lshlrev_b32 v6, 4, v6
    v_lshl_add_u32 v6, v7, 10, v6
    v_lshrrev_b32 v7, 5, v25
    v_lshl_add_u32 v6, v7, 13, v6
    v_lshrrev_b32 v5, 1, v5
    v_lshl_add_u32 v6, v5, 3, v6
    v_add_u32 v18, s36, v6
    v_xor_b32 v19, 8, v18
    v_lshlrev_b32 v31, 4, v2
    s_mov_b32 s56, 0x1000
    s_mov_b32 s57, 0x2000
    s_mov_b32 s58, 0x3000
    s_mov_b32 s59, 0x4e800000
    v_mov_b32 v224, 0
    v_mov_b32 v225, 0
    v_mov_b32 v226, 0
    v_mov_b32 v227, 0
    v_mov_b32 v228, 0
    v_mov_b32 v229, 0
    v_mov_b32 v230, 0
    v_mov_b32 v231, 0
    v_mov_b32 v232, 0
    v_mov_b32 v233, 0
    v_mov_b32 v234, 0
    v_mov_b32 v235, 0
    v_mov_b32 v236, 0
    v_mov_b32 v237, 0
    v_mov_b32 v238, 0
    v_mov_b32 v239, 0
    v_mov_b32 v240, 0
    v_mov_b32 v241, 0
    v_mov_b32 v242, 0
    v_mov_b32 v243, 0
    v_mov_b32 v244, 0
    v_mov_b32 v245, 0
    v_mov_b32 v246, 0
    v_mov_b32 v247, 0
    v_mov_b32 v248, 0
    v_mov_b32 v249, 0
    v_mov_b32 v250, 0
    v_mov_b32 v251, 0
    v_mov_b32 v252, 0
    v_mov_b32 v253, 0
    v_mov_b32 v254, 0
    v_mov_b32 v255, 0
    v_mov_b32 v44, 0
    v_mov_b32 v45, 0
    v_mov_b32 v46, 0
    v_mov_b32 v47, 0
    v_mov_b32 v48, 0
    v_mov_b32 v49, 0
    v_mov_b32 v50, 0
    v_mov_b32 v51, 0
    v_mov_b32 v84, 0
    v_mov_b32 v85, 0
    v_mov_b32 v86, 0
    v_mov_b32 v87, 0
    v_mov_b32 v88, 0
    v_mov_b32 v89, 0
    v_mov_b32 v90, 0
    v_mov_b32 v91, 0
    s_mov_b32 s32, 0
    s_waitcnt lgkmcnt(0)
    s_cmp_eq_u32 s2, s2
    s_branch L_pg
L_pgback:
    s_waitcnt vmcnt(4)
    ds_read_b128 v[192:195], v92 offset:16384
    ds_read_b128 v[196:199], v93 offset:16384
    ds_read_b128 v[200:203], v94 offset:16384
    ds_read_b128 v[204:207], v95 offset:16384
    s_add_u32 m0, s41, 16384
    s_nop 0
    buffer_load_dwordx4 v28, s[24:27], s42 offen nt lds
    buffer_load_dwordx4 v29, s[24:27], s42 offen offset:1024 nt lds
    s_add_u32 m0, s41, 24576
    s_nop 0
    buffer_load_dwordx4 v28, s[24:27], s44 offen nt lds
    buffer_load_dwordx4 v29, s[24:27], s44 offen offset:1024 nt lds
    s_add_u32 m0, s36, 81920
    s_xor_b32 s38, s37, 8192
    buffer_load_dwordx4 v12, s[16:19], s38 offen nt lds
    buffer_load_dwordx4 v13, s[16:19], s38 offen offset:1024 nt lds
    s_add_u32 m0, s36, 90112
    s_xor_b32 s38, s37, 10240
    buffer_load_dwordx4 v14, s[16:19], s38 offen nt lds
    buffer_load_dwordx4 v15, s[16:19], s38 offen offset:1024 nt lds
    s_barrier
    ds_read_b128 a[64:67], v32 offset:49152
    ds_read_b128 a[68:71], v33 offset:49152
    ds_read_b128 a[72:75], v34 offset:49152
    ds_read_b128 a[76:79], v35 offset:49152
    ds_read_b128 a[92:95], v35 offset:53248
    ds_read_b128 a[88:91], v34 offset:53248
    ds_read_b128 a[84:87], v33 offset:53248
    ds_read_b128 a[80:83], v32 offset:53248
    s_waitcnt lgkmcnt(8)
    v_lshlrev_b32 v0, 16, v192
    ds_read_b128 a[96:99], v32 offset:57344
    v_and_b32 v1, 0xffff0000, v192
    ds_read_b128 a[100:103], v33 offset:57344
    v_pk_mul_f32 v[0:1], v[0:1], s[34:35]
    ds_read_b128 a[104:107], v34 offset:57344
    v_cvt_pk_bf16_f32 v8, v0, v1
    ds_read_b128 a[108:111], v35 offset:57344
    v_accvgpr_write_b32 a0, v8
    ds_read_b128 a[124:127], v35 offset:61440
    v_lshlrev_b32 v2, 16, v193
    ds_read_b128 a[120:123], v34 offset:61440
    v_and_b32 v3, 0xffff0000, v193
    ds_read_b128 a[116:119], v33 offset:61440
    v_pk_mul_f32 v[2:3], v[2:3], s[34:35]
    ds_read_b128 a[112:115], v32 offset:61440
    v_cvt_pk_bf16_f32 v9, v2, v3
    v_accvgpr_write_b32 a1, v9
    v_lshlrev_b32 v4, 16, v194
    v_and_b32 v5, 0xffff0000, v194
    v_pk_mul_f32 v[4:5], v[4:5], s[34:35]
    v_cvt_pk_bf16_f32 v10, v4, v5
    v_accvgpr_write_b32 a2, v10
    v_lshlrev_b32 v6, 16, v195
    v_and_b32 v7, 0xffff0000, v195
    v_pk_mul_f32 v[6:7], v[6:7], s[34:35]
    v_cvt_pk_bf16_f32 v11, v6, v7
    v_accvgpr_write_b32 a3, v11
    v_lshlrev_b32 v0, 16, v196
    v_and_b32 v1, 0xffff0000, v196
    v_pk_mul_f32 v[0:1], v[0:1], s[34:35]
    v_cvt_pk_bf16_f32 v8, v0, v1
    v_accvgpr_write_b32 a4, v8
    v_lshlrev_b32 v2, 16, v197
    v_and_b32 v3, 0xffff0000, v197
    v_pk_mul_f32 v[2:3], v[2:3], s[34:35]
    v_cvt_pk_bf16_f32 v9, v2, v3
    v_accvgpr_write_b32 a5, v9
    v_lshlrev_b32 v4, 16, v198
    v_and_b32 v5, 0xffff0000, v198
    v_pk_mul_f32 v[4:5], v[4:5], s[34:35]
    v_cvt_pk_bf16_f32 v10, v4, v5
    v_accvgpr_write_b32 a6, v10
    v_lshlrev_b32 v6, 16, v199
    v_and_b32 v7, 0xffff0000, v199
    v_pk_mul_f32 v[6:7], v[6:7], s[34:35]
    v_cvt_pk_bf16_f32 v11, v6, v7
    v_accvgpr_write_b32 a7, v11
    v_lshlrev_b32 v0, 16, v200
    v_and_b32 v1, 0xffff0000, v200
    v_pk_mul_f32 v[0:1], v[0:1], s[34:35]
    v_cvt_pk_bf16_f32 v8, v0, v1
    v_accvgpr_write_b32 a8, v8
    v_lshlrev_b32 v2, 16, v201
    v_and_b32 v3, 0xffff0000, v201
    v_pk_mul_f32 v[2:3], v[2:3], s[34:35]
    v_cvt_pk_bf16_f32 v9, v2, v3
    v_accvgpr_write_b32 a9, v9
    v_lshlrev_b32 v4, 16, v202
    v_and_b32 v5, 0xffff0000, v202
    v_pk_mul_f32 v[4:5], v[4:5], s[34:35]
    v_cvt_pk_bf16_f32 v10, v4, v5
    v_accvgpr_write_b32 a10, v10
    v_lshlrev_b32 v6, 16, v203
    v_and_b32 v7, 0xffff0000, v203
    v_pk_mul_f32 v[6:7], v[6:7], s[34:35]
    v_cvt_pk_bf16_f32 v11, v6, v7
    v_accvgpr_write_b32 a11, v11
    v_lshlrev_b32 v0, 16, v204
    v_and_b32 v1, 0xffff0000, v204
    v_pk_mul_f32 v[0:1], v[0:1], s[34:35]
    v_cvt_pk_bf16_f32 v8, v0, v1
    v_accvgpr_write_b32 a12, v8
    v_lshlrev_b32 v2, 16, v205
    v_and_b32 v3, 0xffff0000, v205
    v_pk_mul_f32 v[2:3], v[2:3], s[34:35]
    v_cvt_pk_bf16_f32 v9, v2, v3
    v_accvgpr_write_b32 a13, v9
    v_lshlrev_b32 v4, 16, v206
    v_and_b32 v5, 0xffff0000, v206
    v_pk_mul_f32 v[4:5], v[4:5], s[34:35]
    v_cvt_pk_bf16_f32 v10, v4, v5
    v_accvgpr_write_b32 a14, v10
    v_lshlrev_b32 v6, 16, v207
    v_and_b32 v7, 0xffff0000, v207
    v_pk_mul_f32 v[6:7], v[6:7], s[34:35]
    v_cvt_pk_bf16_f32 v11, v6, v7
    v_accvgpr_write_b32 a15, v11
    s_waitcnt vmcnt(8)
    ds_read_b128 v[208:211], v92 offset:32768
    ds_read_b128 v[212:215], v93 offset:32768
    ds_read_b128 v[216:219], v94 offset:32768
    ds_read_b128 v[220:223], v95 offset:32768
    s_add_u32 m0, s36, 98304
    s_xor_b32 s38, s37, 12288
    buffer_load_dwordx4 v12, s[16:19], s38 offen nt lds
    buffer_load_dwordx4 v13, s[16:19], s38 offen offset:1024 nt lds
    s_add_u32 m0, s36, 106496
    s_xor_b32 s38, s37, 14336
    buffer_load_dwordx4 v14, s[16:19], s38 offen nt lds
    buffer_load_dwordx4 v15, s[16:19], s38 offen offset:1024 nt lds
    v_add_u32 v92, 0x10000, v92
    v_add_u32 v93, 0x10000, v93
    v_add_u32 v94, 0x10000, v94
    v_add_u32 v95, 0x10000, v95
    s_waitcnt lgkmcnt(14)
    v_mfma_f32_16x16x32_bf16 v[96:99], a[64:67], a[0:3], 0
    v_mfma_f32_16x16x32_bf16 v[96:99], a[68:71], a[4:7], v[96:99]
    v_mfma_f32_16x16x32_bf16 v[96:99], a[72:75], a[8:11], v[96:99]
    v_mfma_f32_16x16x32_bf16 v[96:99], a[76:79], a[12:15], v[96:99]
    s_waitcnt lgkmcnt(0)
    v_mfma_f32_16x16x32_bf16 v[100:103], a[92:95], a[12:15], 0
    v_lshlrev_b32 v0, 16, v208
    v_and_b32 v1, 0xffff0000, v208
    v_pk_mul_f32 v[0:1], v[0:1], s[34:35]
    v_cvt_pk_bf16_f32 v8, v0, v1
    v_accvgpr_write_b32 a16, v8
    v_lshlrev_b32 v2, 16, v209
    v_mfma_f32_16x16x32_bf16 v[100:103], a[88:91], a[8:11], v[100:103]
    v_and_b32 v3, 0xffff0000, v209
    v_pk_mul_f32 v[2:3], v[2:3], s[34:35]
    v_cvt_pk_bf16_f32 v9, v2, v3
    v_accvgpr_write_b32 a17, v9
    v_lshlrev_b32 v4, 16, v210
    v_and_b32 v5, 0xffff0000, v210
    v_pk_mul_f32 v[4:5], v[4:5], s[34:35]
    v_mfma_f32_16x16x32_bf16 v[100:103], a[84:87], a[4:7], v[100:103]
    v_cvt_pk_bf16_f32 v10, v4, v5
    v_accvgpr_write_b32 a18, v10
    v_lshlrev_b32 v6, 16, v211
    v_and_b32 v7, 0xffff0000, v211
    v_pk_mul_f32 v[6:7], v[6:7], s[34:35]
    v_cvt_pk_bf16_f32 v11, v6, v7
    v_accvgpr_write_b32 a19, v11
    v_mfma_f32_16x16x32_bf16 v[100:103], a[80:83], a[0:3], v[100:103]
    v_lshlrev_b32 v0, 16, v212
    v_and_b32 v1, 0xffff0000, v212
    v_pk_mul_f32 v[0:1], v[0:1], s[34:35]
    v_cvt_pk_bf16_f32 v8, v0, v1
    v_accvgpr_write_b32 a20, v8
    v_lshlrev_b32 v2, 16, v213
    v_mfma_f32_16x16x32_bf16 v[104:107], a[96:99], a[0:3], 0
    v_and_b32 v3, 0xffff0000, v213
    v_pk_mul_f32 v[2:3], v[2:3], s[34:35]
    v_cvt_pk_bf16_f32 v9, v2, v3
    v_accvgpr_write_b32 a21, v9
    v_lshlrev_b32 v4, 16, v214
    v_and_b32 v5, 0xffff0000, v214
    v_pk_mul_f32 v[4:5], v[4:5], s[34:35]
    v_mfma_f32_16x16x32_bf16 v[104:107], a[100:103], a[4:7], v[104:107]
    v_cvt_pk_bf16_f32 v10, v4, v5
    v_accvgpr_write_b32 a22, v10
    v_lshlrev_b32 v6, 16, v215
    v_and_b32 v7, 0xffff0000, v215
    v_pk_mul_f32 v[6:7], v[6:7], s[34:35]
    v_cvt_pk_bf16_f32 v11, v6, v7
    v_accvgpr_write_b32 a23, v11
    v_mfma_f32_16x16x32_bf16 v[104:107], a[104:107], a[8:11], v[104:107]
    v_lshlrev_b32 v0, 16, v216
    v_and_b32 v1, 0xffff0000, v216
    v_pk_mul_f32 v[0:1], v[0:1], s[34:35]
    v_cvt_pk_bf16_f32 v8, v0, v1
    v_accvgpr_write_b32 a24, v8
    v_lshlrev_b32 v2, 16, v217
    v_mfma_f32_16x16x32_bf16 v[104:107], a[108:111], a[12:15], v[104:107]
    v_and_b32 v3, 0xffff0000, v217
    v_pk_mul_f32 v[2:3], v[2:3], s[34:35]
    v_cvt_pk_bf16_f32 v9, v2, v3
    v_accvgpr_write_b32 a25, v9
    v_lshlrev_b32 v4, 16, v218
    v_and_b32 v5, 0xffff0000, v218
    v_pk_mul_f32 v[4:5], v[4:5], s[34:35]
    v_mfma_f32_16x16x32_bf16 v[108:111], a[124:127], a[12:15], 0
    v_cvt_pk_bf16_f32 v10, v4, v5
    v_accvgpr_write_b32 a26, v10
    v_lshlrev_b32 v6, 16, v219
    v_and_b32 v7, 0xffff0000, v219
    v_pk_mul_f32 v[6:7], v[6:7], s[34:35]
    v_cvt_pk_bf16_f32 v11, v6, v7
    v_accvgpr_write_b32 a27, v11
    v_mfma_f32_16x16x32_bf16 v[108:111], a[120:123], a[8:11], v[108:111]
    v_lshlrev_b32 v0, 16, v220
    v_and_b32 v1, 0xffff0000, v220
    v_pk_mul_f32 v[0:1], v[0:1], s[34:35]
    v_cvt_pk_bf16_f32 v8, v0, v1
    v_accvgpr_write_b32 a28, v8
    v_lshlrev_b32 v2, 16, v221
    v_mfma_f32_16x16x32_bf16 v[108:111], a[116:119], a[4:7], v[108:111]
    v_and_b32 v3, 0xffff0000, v221
    v_pk_mul_f32 v[2:3], v[2:3], s[34:35]
    v_cvt_pk_bf16_f32 v9, v2, v3
    v_accvgpr_write_b32 a29, v9
    v_lshlrev_b32 v4, 16, v222
    v_and_b32 v5, 0xffff0000, v222
    v_pk_mul_f32 v[4:5], v[4:5], s[34:35]
    v_mfma_f32_16x16x32_bf16 v[108:111], a[112:115], a[0:3], v[108:111]
    v_cvt_pk_bf16_f32 v10, v4, v5
    v_accvgpr_write_b32 a30, v10
    v_lshlrev_b32 v6, 16, v223
    v_and_b32 v7, 0xffff0000, v223
    v_pk_mul_f32 v[6:7], v[6:7], s[34:35]
    v_cvt_pk_bf16_f32 v11, v6, v7
    v_accvgpr_write_b32 a31, v11
    v_max3_f32 v0, v96, v97, v98
    v_max3_f32 v1, v99, v100, v101
    v_max3_f32 v0, v0, v102, v103
    v_max3_f32 v1, v1, v104, v105
    v_max3_f32 v0, v0, v106, v107
    v_max3_f32 v1, v1, v108, v109
    v_max3_f32 v0, v0, v110, v111
    v_max_f32 v0, v0, v1
    v_mov_b32 v1, v0
    s_nop 1
    v_permlane16_swap_b32 v0, v1
    v_max_f32 v0, v0, v1
    v_mov_b32 v1, v0
    s_nop 1
    v_permlane32_swap_b32 v0, v1
    v_max_f32 v0, v0, v1
    v_sub_f32 v96, v96, v0
    v_sub_f32 v97, v97, v0
    v_sub_f32 v98, v98, v0
    v_sub_f32 v99, v99, v0
    v_sub_f32 v100, v100, v0
    v_sub_f32 v101, v101, v0
    v_sub_f32 v102, v102, v0
    v_sub_f32 v103, v103, v0
    v_sub_f32 v104, v104, v0
    v_sub_f32 v105, v105, v0
    v_sub_f32 v106, v106, v0
    v_sub_f32 v107, v107, v0
    v_sub_f32 v108, v108, v0
    v_sub_f32 v109, v109, v0
    v_sub_f32 v110, v110, v0
    v_sub_f32 v111, v111, v0
    v_sub_f32 v68, 0, v0
    v_sub_f32 v69, 0, v0
    v_sub_f32 v70, 0, v0
    v_sub_f32 v71, 0, v0
    v_mfma_f32_16x16x32_bf16 v[112:115], a[64:67], a[16:19], 0
    v_exp_f32 v96, v96
    v_mfma_f32_16x16x32_bf16 v[112:115], a[68:71], a[20:23], v[112:115]
    v_exp_f32 v97, v97
    v_exp_f32 v98, v98
    v_mfma_f32_16x16x32_bf16 v[112:115], a[72:75], a[24:27], v[112:115]
    v_cvt_pk_bf16_f32 v52, v96, v97
    v_mfma_f32_16x16x32_bf16 v[112:115], a[76:79], a[28:31], v[112:115]
    v_exp_f32 v99, v99
    v_exp_f32 v100, v100
    v_mfma_f32_16x16x32_bf16 v[116:119], a[92:95], a[28:31], 0
    v_cvt_pk_bf16_f32 v53, v98, v99
    v_mfma_f32_16x16x32_bf16 v[116:119], a[88:91], a[24:27], v[116:119]
    v_exp_f32 v101, v101
    v_exp_f32 v102, v102
    v_mfma_f32_16x16x32_bf16 v[116:119], a[84:87], a[20:23], v[116:119]
    v_cvt_pk_bf16_f32 v54, v100, v101
    v_mfma_f32_16x16x32_bf16 v[116:119], a[80:83], a[16:19], v[116:119]
    v_exp_f32 v103, v103
    v_exp_f32 v104, v104
    v_mfma_f32_16x16x32_bf16 v[120:123], a[96:99], a[16:19], 0
    v_cvt_pk_bf16_f32 v55, v102, v103
    v_exp_f32 v105, v105
    v_mfma_f32_16x16x32_bf16 v[120:123], a[100:103], a[20:23], v[120:123]
    v_exp_f32 v106, v106
    v_mfma_f32_16x16x32_bf16 v[120:123], a[104:107], a[24:27], v[120:123]
    v_cvt_pk_bf16_f32 v56, v104, v105
    v_exp_f32 v107, v107
    v_mfma_f32_16x16x32_bf16 v[120:123], a[108:111], a[28:31], v[120:123]
    v_exp_f32 v108, v108
    v_mfma_f32_16x16x32_bf16 v[124:127], a[124:127], a[28:31], 0
    v_cvt_pk_bf16_f32 v57, v106, v107
    v_exp_f32 v109, v109
    v_mfma_f32_16x16x32_bf16 v[124:127], a[120:123], a[24:27], v[124:127]
    v_exp_f32 v110, v110
    v_mfma_f32_16x16x32_bf16 v[124:127], a[116:119], a[20:23], v[124:127]
    v_cvt_pk_bf16_f32 v58, v108, v109
    v_exp_f32 v111, v111
    v_mfma_f32_16x16x32_bf16 v[124:127], a[112:115], a[16:19], v[124:127]
    s_nop 0
    v_cvt_pk_bf16_f32 v59, v110, v111
    s_waitcnt vmcnt(8)
    s_barrier
    ds_read_b64_tr_b16 a[128:129], v36 offset:49152
    ds_read_b64_tr_b16 a[130:131], v36 offset:53248
    ds_read_b64_tr_b16 a[132:133], v36 offset:57344
    ds_read_b64_tr_b16 a[134:135], v36 offset:61440
    ds_read_b64_tr_b16 a[136:137], v37 offset:49152
    ds_read_b64_tr_b16 a[138:139], v37 offset:53248
    ds_read_b64_tr_b16 a[140:141], v37 offset:57344
    ds_read_b64_tr_b16 a[142:143], v37 offset:61440
    ds_read_b64_tr_b16 a[144:145], v38 offset:49152
    ds_read_b64_tr_b16 a[146:147], v38 offset:53248
    ds_read_b64_tr_b16 a[148:149], v38 offset:57344
    ds_read_b64_tr_b16 a[150:151], v38 offset:61440
    s_xor_b32 s40, s40, 0x8000
    s_xor_b32 s41, s41, 0x8000
    s_add_u32 m0, s40, 0
    s_nop 0
    buffer_load_dwordx4 v26, s[20:23], s43 offen nt lds
    buffer_load_dwordx4 v27, s[20:23], s43 offen offset:1024 nt lds
    s_add_u32 m0, s40, 8192
    s_nop 0
    buffer_load_dwordx4 v26, s[20:23], s45 offen nt lds
    buffer_load_dwordx4 v27, s[20:23], s45 offen offset:1024 nt lds
    v_max3_f32 v0, v112, v113, v114
    v_max3_f32 v1, v115, v116, v117
    v_max3_f32 v0, v0, v118, v119
    v_max3_f32 v1, v1, v120, v121
    v_max3_f32 v0, v0, v122, v123
    v_max3_f32 v1, v1, v124, v125
    v_max3_f32 v0, v0, v126, v127
    v_max_f32 v0, v0, v1
    v_mov_b32 v1, v0
    s_nop 1
    v_permlane16_swap_b32 v0, v1
    v_max_f32 v0, v0, v1
    v_mov_b32 v1, v0
    s_nop 1
    v_permlane32_swap_b32 v0, v1
    v_max_f32 v0, v0, v1
    s_waitcnt lgkmcnt(4)
    ds_read_b64_tr_b16 a[152:153], v39 offset:49152
    ds_read_b64_tr_b16 a[154:155], v39 offset:53248
    ds_read_b64_tr_b16 a[156:157], v39 offset:57344
    ds_read_b64_tr_b16 a[158:159], v39 offset:61440
    ds_read_b64_tr_b16 a[160:161], v40 offset:49152
    ds_read_b64_tr_b16 a[162:163], v40 offset:53248
    ds_read_b64_tr_b16 a[164:165], v40 offset:57344
    ds_read_b64_tr_b16 a[166:167], v40 offset:61440
    ds_read_b64_tr_b16 a[168:169], v41 offset:49152
    ds_read_b64_tr_b16 a[170:171], v41 offset:53248
    v_sub_f32 v112, v112, v0
    v_sub_f32 v113, v113, v0
    v_sub_f32 v114, v114, v0
    v_sub_f32 v115, v115, v0
    v_sub_f32 v116, v116, v0
    v_sub_f32 v117, v117, v0
    v_sub_f32 v118, v118, v0
    v_sub_f32 v119, v119, v0
    v_sub_f32 v120, v120, v0
    v_sub_f32 v121, v121, v0
    v_sub_f32 v122, v122, v0
    v_sub_f32 v123, v123, v0
    v_sub_f32 v124, v124, v0
    v_sub_f32 v125, v125, v0
    v_sub_f32 v126, v126, v0
    v_sub_f32 v127, v127, v0
    v_sub_f32 v72, 0, v0
    v_sub_f32 v73, 0, v0
    v_sub_f32 v74, 0, v0
    v_sub_f32 v75, 0, v0
    s_waitcnt lgkmcnt(4)
    ds_read_b64_tr_b16 a[172:173], v41 offset:57344
    ds_read_b64_tr_b16 a[174:175], v41 offset:61440
    ds_read_b64_tr_b16 a[176:177], v42 offset:49152
    ds_read_b64_tr_b16 a[178:179], v42 offset:53248
    ds_read_b64_tr_b16 a[180:181], v42 offset:57344
    ds_read_b64_tr_b16 a[182:183], v42 offset:61440
    ds_read_b64_tr_b16 a[184:185], v43 offset:49152
    ds_read_b64_tr_b16 a[186:187], v43 offset:53248
    ds_read_b64_tr_b16 a[188:189], v43 offset:57344
    ds_read_b64_tr_b16 a[190:191], v43 offset:61440
    s_waitcnt vmcnt(8)
    s_waitcnt lgkmcnt(8)
    ds_read_b128 v[192:195], v92 offset:16384
    ds_read_b128 v[196:199], v93 offset:16384
    ds_read_b128 v[200:203], v94 offset:16384
    ds_read_b128 v[204:207], v95 offset:16384
    s_add_u32 m0, s41, 0
    s_nop 0
    buffer_load_dwordx4 v28, s[24:27], s43 offen nt lds
    buffer_load_dwordx4 v29, s[24:27], s43 offen offset:1024 nt lds
    s_add_u32 m0, s41, 8192
    s_nop 0
    buffer_load_dwordx4 v28, s[24:27], s45 offen nt lds
    buffer_load_dwordx4 v29, s[24:27], s45 offen offset:1024 nt lds
    s_waitcnt lgkmcnt(4)
    v_smfmac_f32_16x16x64_bf16 v[44:47], v[20:23], v[52:59], v24
    v_exp_f32 v112, v112
    v_mfma_f32_16x16x32_bf16 v[128:131], v[52:55], a[128:131], 0
    v_exp_f32 v113, v113
    v_mfma_f32_16x16x32_bf16 v[128:131], v[56:59], a[132:135], v[128:131]
    v_exp_f32 v114, v114
    v_cvt_pk_bf16_f32 v60, v112, v113
    v_mfma_f32_16x16x32_bf16 v[132:135], v[52:55], a[136:139], 0
    v_exp_f32 v115, v115
    v_mfma_f32_16x16x32_bf16 v[132:135], v[56:59], a[140:143], v[132:135]
    v_exp_f32 v116, v116
    v_cvt_pk_bf16_f32 v61, v114, v115
    v_mfma_f32_16x16x32_bf16 v[136:139], v[52:55], a[144:147], 0
    v_exp_f32 v117, v117
    v_mfma_f32_16x16x32_bf16 v[136:139], v[56:59], a[148:151], v[136:139]
    v_exp_f32 v118, v118
    v_cvt_pk_bf16_f32 v62, v116, v117
    v_mfma_f32_16x16x32_bf16 v[140:143], v[52:55], a[152:155], 0
    v_exp_f32 v119, v119
    v_mfma_f32_16x16x32_bf16 v[140:143], v[56:59], a[156:159], v[140:143]
    v_exp_f32 v120, v120
    v_cvt_pk_bf16_f32 v63, v118, v119
    v_mfma_f32_16x16x32_bf16 v[144:147], v[52:55], a[160:163], 0
    v_exp_f32 v121, v121
    v_mfma_f32_16x16x32_bf16 v[144:147], v[56:59], a[164:167], v[144:147]
    v_exp_f32 v122, v122
    v_cvt_pk_bf16_f32 v64, v120, v121
    v_mfma_f32_16x16x32_bf16 v[148:151], v[52:55], a[168:171], 0
    v_exp_f32 v123, v123
    v_mfma_f32_16x16x32_bf16 v[148:151], v[56:59], a[172:175], v[148:151]
    v_exp_f32 v124, v124
    v_cvt_pk_bf16_f32 v65, v122, v123
    v_mfma_f32_16x16x32_bf16 v[152:155], v[52:55], a[176:179], 0
    v_exp_f32 v125, v125
    v_mfma_f32_16x16x32_bf16 v[152:155], v[56:59], a[180:183], v[152:155]
    v_exp_f32 v126, v126
    v_cvt_pk_bf16_f32 v66, v124, v125
    v_mfma_f32_16x16x32_bf16 v[156:159], v[52:55], a[184:187], 0
    v_exp_f32 v127, v127
    v_mfma_f32_16x16x32_bf16 v[156:159], v[56:59], a[188:191], v[156:159]
    s_nop 0
    v_cvt_pk_bf16_f32 v67, v126, v127
    s_waitcnt lgkmcnt(0)
    v_lshlrev_b32 v0, 16, v192
    v_and_b32 v1, 0xffff0000, v192
    v_pk_mul_f32 v[0:1], v[0:1], s[34:35]
    v_cvt_pk_bf16_f32 v8, v0, v1
    v_accvgpr_write_b32 a32, v8
    v_lshlrev_b32 v2, 16, v193
    v_and_b32 v3, 0xffff0000, v193
    v_pk_mul_f32 v[2:3], v[2:3], s[34:35]
    v_cvt_pk_bf16_f32 v9, v2, v3
    v_accvgpr_write_b32 a33, v9
    v_lshlrev_b32 v4, 16, v194
    v_and_b32 v5, 0xffff0000, v194
    v_pk_mul_f32 v[4:5], v[4:5], s[34:35]
    v_cvt_pk_bf16_f32 v10, v4, v5
    v_accvgpr_write_b32 a34, v10
    v_lshlrev_b32 v6, 16, v195
    v_and_b32 v7, 0xffff0000, v195
    v_pk_mul_f32 v[6:7], v[6:7], s[34:35]
    v_cvt_pk_bf16_f32 v11, v6, v7
    v_accvgpr_write_b32 a35, v11
    v_lshlrev_b32 v0, 16, v196
    v_and_b32 v1, 0xffff0000, v196
    v_pk_mul_f32 v[0:1], v[0:1], s[34:35]
    v_cvt_pk_bf16_f32 v8, v0, v1
    v_accvgpr_write_b32 a36, v8
    v_lshlrev_b32 v2, 16, v197
    v_and_b32 v3, 0xffff0000, v197
    v_pk_mul_f32 v[2:3], v[2:3], s[34:35]
    v_cvt_pk_bf16_f32 v9, v2, v3
    v_accvgpr_write_b32 a37, v9
    v_lshlrev_b32 v4, 16, v198
    v_and_b32 v5, 0xffff0000, v198
    v_pk_mul_f32 v[4:5], v[4:5], s[34:35]
    v_cvt_pk_bf16_f32 v10, v4, v5
    v_accvgpr_write_b32 a38, v10
    v_lshlrev_b32 v6, 16, v199
    v_and_b32 v7, 0xffff0000, v199
    v_pk_mul_f32 v[6:7], v[6:7], s[34:35]
    v_cvt_pk_bf16_f32 v11, v6, v7
    v_accvgpr_write_b32 a39, v11
    v_lshlrev_b32 v0, 16, v200
    v_and_b32 v1, 0xffff0000, v200
    v_pk_mul_f32 v[0:1], v[0:1], s[34:35]
    v_cvt_pk_bf16_f32 v8, v0, v1
    v_accvgpr_write_b32 a40, v8
    v_lshlrev_b32 v2, 16, v201
    v_and_b32 v3, 0xffff0000, v201
    v_pk_mul_f32 v[2:3], v[2:3], s[34:35]
    v_cvt_pk_bf16_f32 v9, v2, v3
    v_accvgpr_write_b32 a41, v9
    v_lshlrev_b32 v4, 16, v202
    v_and_b32 v5, 0xffff0000, v202
    v_pk_mul_f32 v[4:5], v[4:5], s[34:35]
    v_cvt_pk_bf16_f32 v10, v4, v5
    v_accvgpr_write_b32 a42, v10
    v_lshlrev_b32 v6, 16, v203
    v_and_b32 v7, 0xffff0000, v203
    v_pk_mul_f32 v[6:7], v[6:7], s[34:35]
    v_cvt_pk_bf16_f32 v11, v6, v7
    v_accvgpr_write_b32 a43, v11
    v_lshlrev_b32 v0, 16, v204
    v_and_b32 v1, 0xffff0000, v204
    v_pk_mul_f32 v[0:1], v[0:1], s[34:35]
    v_cvt_pk_bf16_f32 v8, v0, v1
    v_accvgpr_write_b32 a44, v8
    v_lshlrev_b32 v2, 16, v205
    v_and_b32 v3, 0xffff0000, v205
    v_pk_mul_f32 v[2:3], v[2:3], s[34:35]
    v_cvt_pk_bf16_f32 v9, v2, v3
    v_accvgpr_write_b32 a45, v9
    v_lshlrev_b32 v4, 16, v206
    v_and_b32 v5, 0xffff0000, v206
    v_pk_mul_f32 v[4:5], v[4:5], s[34:35]
    v_cvt_pk_bf16_f32 v10, v4, v5
    v_accvgpr_write_b32 a46, v10
    v_lshlrev_b32 v6, 16, v207
    v_and_b32 v7, 0xffff0000, v207
    v_pk_mul_f32 v[6:7], v[6:7], s[34:35]
    v_cvt_pk_bf16_f32 v11, v6, v7
    v_accvgpr_write_b32 a47, v11
    s_add_u32 s33, s33, 0x1000
    s_or_b32 s33, s33, 0x18000
    s_xor_b32 s42, s33, s46
    s_xor_b32 s44, s42, 0x800
    v_mfma_f32_16x16x32_bf16 v[96:99], a[64:67], a[32:35], 0
    v_mfma_f32_16x16x32_bf16 v[96:99], a[68:71], a[36:39], v[96:99]
    v_mfma_f32_16x16x32_bf16 v[96:99], a[72:75], a[40:43], v[96:99]
    v_mfma_f32_16x16x32_bf16 v[96:99], a[76:79], a[44:47], v[96:99]
    v_mfma_f32_16x16x32_bf16 v[100:103], a[92:95], a[44:47], 0
    v_mfma_f32_16x16x32_bf16 v[100:103], a[88:91], a[40:43], v[100:103]
    v_mfma_f32_16x16x32_bf16 v[100:103], a[84:87], a[36:39], v[100:103]
    v_mfma_f32_16x16x32_bf16 v[100:103], a[80:83], a[32:35], v[100:103]
    v_mfma_f32_16x16x32_bf16 v[104:107], a[96:99], a[32:35], 0
    v_mfma_f32_16x16x32_bf16 v[104:107], a[100:103], a[36:39], v[104:107]
    v_mfma_f32_16x16x32_bf16 v[104:107], a[104:107], a[40:43], v[104:107]
    v_mfma_f32_16x16x32_bf16 v[104:107], a[108:111], a[44:47], v[104:107]
    v_mfma_f32_16x16x32_bf16 v[108:111], a[124:127], a[44:47], 0
    v_mfma_f32_16x16x32_bf16 v[108:111], a[120:123], a[40:43], v[108:111]
    v_mfma_f32_16x16x32_bf16 v[108:111], a[116:119], a[36:39], v[108:111]
    v_mfma_f32_16x16x32_bf16 v[108:111], a[112:115], a[32:35], v[108:111]
    v_smfmac_f32_16x16x64_bf16 v[48:51], v[20:23], v[60:67], v24
    v_mfma_f32_16x16x32_bf16 v[160:163], v[60:63], a[128:131], 0
    v_mfma_f32_16x16x32_bf16 v[160:163], v[64:67], a[132:135], v[160:163]
    v_mfma_f32_16x16x32_bf16 v[164:167], v[60:63], a[136:139], 0
    v_mfma_f32_16x16x32_bf16 v[164:167], v[64:67], a[140:143], v[164:167]
    v_max3_f32 v0, v96, v97, v98
    v_max3_f32 v1, v99, v100, v101
    v_mfma_f32_16x16x32_bf16 v[168:171], v[60:63], a[144:147], 0
    v_max3_f32 v0, v0, v102, v103
    v_max3_f32 v1, v1, v104, v105
    v_max3_f32 v0, v0, v106, v107
    v_mfma_f32_16x16x32_bf16 v[168:171], v[64:67], a[148:151], v[168:171]
    v_max3_f32 v1, v1, v108, v109
    v_max3_f32 v0, v0, v110, v111
    v_max_f32 v0, v0, v1
    v_mfma_f32_16x16x32_bf16 v[172:175], v[60:63], a[152:155], 0
    v_mov_b32 v1, v0
    s_nop 1
    v_permlane16_swap_b32 v0, v1
    v_mfma_f32_16x16x32_bf16 v[172:175], v[64:67], a[156:159], v[172:175]
    v_max_f32 v0, v0, v1
    v_mov_b32 v1, v0
    v_mfma_f32_16x16x32_bf16 v[176:179], v[60:63], a[160:163], 0
    s_nop 1
    v_permlane32_swap_b32 v0, v1
    v_max_f32 v0, v0, v1
    v_mfma_f32_16x16x32_bf16 v[176:179], v[64:67], a[164:167], v[176:179]
    v_sub_f32 v96, v96, v0
    v_sub_f32 v97, v97, v0
    v_sub_f32 v98, v98, v0
    v_mfma_f32_16x16x32_bf16 v[180:183], v[60:63], a[168:171], 0
    v_sub_f32 v99, v99, v0
    v_sub_f32 v100, v100, v0
    v_sub_f32 v101, v101, v0
    v_mfma_f32_16x16x32_bf16 v[180:183], v[64:67], a[172:175], v[180:183]
    v_sub_f32 v102, v102, v0
    v_sub_f32 v103, v103, v0
    v_mfma_f32_16x16x32_bf16 v[184:187], v[60:63], a[176:179], 0
    v_sub_f32 v104, v104, v0
    v_sub_f32 v105, v105, v0
    v_sub_f32 v106, v106, v0
    v_mfma_f32_16x16x32_bf16 v[184:187], v[64:67], a[180:183], v[184:187]
    v_sub_f32 v107, v107, v0
    v_sub_f32 v108, v108, v0
    v_sub_f32 v109, v109, v0
    v_mfma_f32_16x16x32_bf16 v[188:191], v[60:63], a[184:187], 0
    v_sub_f32 v110, v110, v0
    v_sub_f32 v111, v111, v0
    v_sub_f32 v76, 0, v0
    v_mfma_f32_16x16x32_bf16 v[188:191], v[64:67], a[188:191], v[188:191]
    v_sub_f32 v77, 0, v0
    v_sub_f32 v78, 0, v0
    v_sub_f32 v79, 0, v0
    s_waitcnt vmcnt(8)
    ds_read_b128 v[208:211], v92 offset:32768
    ds_read_b128 v[212:215], v93 offset:32768
    ds_read_b128 v[216:219], v94 offset:32768
    ds_read_b128 v[220:223], v95 offset:32768
    s_add_u32 m0, s40, 16384
    s_nop 0
    buffer_load_dwordx4 v26, s[20:23], s42 offen nt lds
    buffer_load_dwordx4 v27, s[20:23], s42 offen offset:1024 nt lds
    s_add_u32 m0, s40, 24576
    s_nop 0
    buffer_load_dwordx4 v26, s[20:23], s44 offen nt lds
    buffer_load_dwordx4 v27, s[20:23], s44 offen offset:1024 nt lds
    v_exp_f32 v96, v96
    v_exp_f32 v97, v97
    v_exp_f32 v98, v98
    v_cvt_pk_bf16_f32 v52, v96, v97
    v_exp_f32 v99, v99
    v_exp_f32 v100, v100
    v_cvt_pk_bf16_f32 v53, v98, v99
    v_exp_f32 v101, v101
    v_exp_f32 v102, v102
    v_cvt_pk_bf16_f32 v54, v100, v101
    v_exp_f32 v103, v103
    v_exp_f32 v104, v104
    v_cvt_pk_bf16_f32 v55, v102, v103
    v_exp_f32 v105, v105
    v_exp_f32 v106, v106
    v_cvt_pk_bf16_f32 v56, v104, v105
    v_exp_f32 v107, v107
    v_exp_f32 v108, v108
    v_cvt_pk_bf16_f32 v57, v106, v107
    v_exp_f32 v109, v109
    v_exp_f32 v110, v110
    v_cvt_pk_bf16_f32 v58, v108, v109
    v_exp_f32 v111, v111
    s_nop 0
    v_cvt_pk_bf16_f32 v59, v110, v111
    s_waitcnt lgkmcnt(0)
    v_lshlrev_b32 v0, 16, v208
    v_and_b32 v1, 0xffff0000, v208
    v_pk_mul_f32 v[0:1], v[0:1], s[34:35]
    v_cvt_pk_bf16_f32 v8, v0, v1
    v_accvgpr_write_b32 a48, v8
    v_lshlrev_b32 v2, 16, v209
    v_and_b32 v3, 0xffff0000, v209
    v_pk_mul_f32 v[2:3], v[2:3], s[34:35]
    v_cvt_pk_bf16_f32 v9, v2, v3
    v_accvgpr_write_b32 a49, v9
    v_lshlrev_b32 v4, 16, v210
    v_and_b32 v5, 0xffff0000, v210
    v_pk_mul_f32 v[4:5], v[4:5], s[34:35]
    v_cvt_pk_bf16_f32 v10, v4, v5
    v_accvgpr_write_b32 a50, v10
    v_lshlrev_b32 v6, 16, v211
    v_and_b32 v7, 0xffff0000, v211
    v_pk_mul_f32 v[6:7], v[6:7], s[34:35]
    v_cvt_pk_bf16_f32 v11, v6, v7
    v_accvgpr_write_b32 a51, v11
    v_lshlrev_b32 v0, 16, v212
    v_and_b32 v1, 0xffff0000, v212
    v_pk_mul_f32 v[0:1], v[0:1], s[34:35]
    v_cvt_pk_bf16_f32 v8, v0, v1
    v_accvgpr_write_b32 a52, v8
    v_lshlrev_b32 v2, 16, v213
    v_and_b32 v3, 0xffff0000, v213
    v_pk_mul_f32 v[2:3], v[2:3], s[34:35]
    v_cvt_pk_bf16_f32 v9, v2, v3
    v_accvgpr_write_b32 a53, v9
    v_lshlrev_b32 v4, 16, v214
    v_and_b32 v5, 0xffff0000, v214
    v_pk_mul_f32 v[4:5], v[4:5], s[34:35]
    v_cvt_pk_bf16_f32 v10, v4, v5
    v_accvgpr_write_b32 a54, v10
    v_lshlrev_b32 v6, 16, v215
    v_and_b32 v7, 0xffff0000, v215
    v_pk_mul_f32 v[6:7], v[6:7], s[34:35]
    v_cvt_pk_bf16_f32 v11, v6, v7
    v_accvgpr_write_b32 a55, v11
    v_lshlrev_b32 v0, 16, v216
    v_and_b32 v1, 0xffff0000, v216
    v_pk_mul_f32 v[0:1], v[0:1], s[34:35]
    v_cvt_pk_bf16_f32 v8, v0, v1
    v_accvgpr_write_b32 a56, v8
    v_lshlrev_b32 v2, 16, v217
    v_and_b32 v3, 0xffff0000, v217
    v_pk_mul_f32 v[2:3], v[2:3], s[34:35]
    v_cvt_pk_bf16_f32 v9, v2, v3
    v_accvgpr_write_b32 a57, v9
    v_lshlrev_b32 v4, 16, v218
    v_and_b32 v5, 0xffff0000, v218
    v_pk_mul_f32 v[4:5], v[4:5], s[34:35]
    v_cvt_pk_bf16_f32 v10, v4, v5
    v_accvgpr_write_b32 a58, v10
    v_lshlrev_b32 v6, 16, v219
    v_and_b32 v7, 0xffff0000, v219
    v_pk_mul_f32 v[6:7], v[6:7], s[34:35]
    v_cvt_pk_bf16_f32 v11, v6, v7
    v_accvgpr_write_b32 a59, v11
    v_lshlrev_b32 v0, 16, v220
    v_and_b32 v1, 0xffff0000, v220
    v_pk_mul_f32 v[0:1], v[0:1], s[34:35]
    v_cvt_pk_bf16_f32 v8, v0, v1
    v_accvgpr_write_b32 a60, v8
    v_lshlrev_b32 v2, 16, v221
    v_and_b32 v3, 0xffff0000, v221
    v_pk_mul_f32 v[2:3], v[2:3], s[34:35]
    v_cvt_pk_bf16_f32 v9, v2, v3
    v_accvgpr_write_b32 a61, v9
    v_lshlrev_b32 v4, 16, v222
    v_and_b32 v5, 0xffff0000, v222
    v_pk_mul_f32 v[4:5], v[4:5], s[34:35]
    v_cvt_pk_bf16_f32 v10, v4, v5
    v_accvgpr_write_b32 a62, v10
    v_lshlrev_b32 v6, 16, v223
    v_and_b32 v7, 0xffff0000, v223
    v_pk_mul_f32 v[6:7], v[6:7], s[34:35]
    v_cvt_pk_bf16_f32 v11, v6, v7
    v_accvgpr_write_b32 a63, v11
    s_nop 0
    v_mfma_f32_16x16x32_bf16 v[112:115], a[64:67], a[48:51], 0
    v_mfma_f32_16x16x32_bf16 v[112:115], a[68:71], a[52:55], v[112:115]
    v_mfma_f32_16x16x32_bf16 v[112:115], a[72:75], a[56:59], v[112:115]
    v_mfma_f32_16x16x32_bf16 v[112:115], a[76:79], a[60:63], v[112:115]
    v_mfma_f32_16x16x32_bf16 v[116:119], a[92:95], a[60:63], 0
    v_mfma_f32_16x16x32_bf16 v[116:119], a[88:91], a[56:59], v[116:119]
    v_mfma_f32_16x16x32_bf16 v[116:119], a[84:87], a[52:55], v[116:119]
    v_mfma_f32_16x16x32_bf16 v[116:119], a[80:83], a[48:51], v[116:119]
    v_mfma_f32_16x16x32_bf16 v[120:123], a[96:99], a[48:51], 0
    v_mfma_f32_16x16x32_bf16 v[120:123], a[100:103], a[52:55], v[120:123]
    v_mfma_f32_16x16x32_bf16 v[120:123], a[104:107], a[56:59], v[120:123]
    v_mfma_f32_16x16x32_bf16 v[120:123], a[108:111], a[60:63], v[120:123]
    v_mfma_f32_16x16x32_bf16 v[124:127], a[124:127], a[60:63], 0
    v_mfma_f32_16x16x32_bf16 v[124:127], a[120:123], a[56:59], v[124:127]
    v_mfma_f32_16x16x32_bf16 v[124:127], a[116:119], a[52:55], v[124:127]
    v_mfma_f32_16x16x32_bf16 v[124:127], a[112:115], a[48:51], v[124:127]
    s_waitcnt vmcnt(8)
    s_barrier
    s_add_u32 m0, s41, 16384
    s_nop 0
    buffer_load_dwordx4 v28, s[24:27], s42 offen nt lds
    buffer_load_dwordx4 v29, s[24:27], s42 offen offset:1024 nt lds
    s_add_u32 m0, s41, 24576
    s_nop 0
    buffer_load_dwordx4 v28, s[24:27], s44 offen nt lds
    buffer_load_dwordx4 v29, s[24:27], s44 offen offset:1024 nt lds
    v_smfmac_f32_16x16x64_bf16 v[84:87], v[20:23], v[52:59], v24
    ds_read_b128 a[64:67], v32 offset:0
    ds_read_b128 a[68:71], v33 offset:0
    ds_read_b128 a[72:75], v34 offset:0
    ds_read_b128 a[76:79], v35 offset:0
    v_mfma_f32_16x16x32_bf16 v[192:195], v[52:55], a[128:131], 0
    ds_read_b128 a[92:95], v35 offset:4096
    ds_read_b128 a[88:91], v34 offset:4096
    ds_read_b128 a[84:87], v33 offset:4096
    ds_read_b128 a[80:83], v32 offset:4096
    v_mfma_f32_16x16x32_bf16 v[192:195], v[56:59], a[132:135], v[192:195]
    v_max3_f32 v4, v112, v113, v114
    v_max3_f32 v5, v115, v116, v117
    v_max3_f32 v4, v4, v118, v119
    v_max3_f32 v5, v5, v120, v121
    v_mfma_f32_16x16x32_bf16 v[196:199], v[52:55], a[136:139], 0
    v_max3_f32 v4, v4, v122, v123
    v_max3_f32 v5, v5, v124, v125
    v_max3_f32 v4, v4, v126, v127
    v_max_f32 v4, v4, v5
    v_mfma_f32_16x16x32_bf16 v[196:199], v[56:59], a[140:143], v[196:199]
    v_mov_b32 v5, v4
    s_nop 1
    v_permlane16_swap_b32 v4, v5
    v_max_f32 v4, v4, v5
    v_mfma_f32_16x16x32_bf16 v[200:203], v[52:55], a[144:147], 0
    v_mov_b32 v5, v4
    s_nop 1
    v_permlane32_swap_b32 v4, v5
    v_max_f32 v4, v4, v5
    ds_read_b128 a[96:99], v32 offset:8192
    v_mfma_f32_16x16x32_bf16 v[200:203], v[56:59], a[148:151], v[200:203]
    ds_read_b128 a[100:103], v33 offset:8192
    ds_read_b128 a[104:107], v34 offset:8192
    ds_read_b128 a[108:111], v35 offset:8192
    ds_read_b128 a[124:127], v35 offset:12288
    v_mfma_f32_16x16x32_bf16 v[204:207], v[52:55], a[152:155], 0
    ds_read_b128 a[120:123], v34 offset:12288
    ds_read_b128 a[116:119], v33 offset:12288
    ds_read_b128 a[112:115], v32 offset:12288
    v_sub_f32 v112, v112, v4
    v_mfma_f32_16x16x32_bf16 v[204:207], v[56:59], a[156:159], v[204:207]
    v_sub_f32 v113, v113, v4
    v_sub_f32 v114, v114, v4
    v_sub_f32 v115, v115, v4
    v_sub_f32 v116, v116, v4
    v_mfma_f32_16x16x32_bf16 v[208:211], v[52:55], a[160:163], 0
    v_sub_f32 v117, v117, v4
    v_sub_f32 v118, v118, v4
    v_sub_f32 v119, v119, v4
    v_sub_f32 v120, v120, v4
    v_mfma_f32_16x16x32_bf16 v[208:211], v[56:59], a[164:167], v[208:211]
    v_sub_f32 v121, v121, v4
    v_sub_f32 v122, v122, v4
    v_sub_f32 v123, v123, v4
    v_sub_f32 v124, v124, v4
    v_mfma_f32_16x16x32_bf16 v[212:215], v[52:55], a[168:171], 0
    v_sub_f32 v125, v125, v4
    v_sub_f32 v126, v126, v4
    v_sub_f32 v127, v127, v4
    v_sub_f32 v80, 0, v4
    v_sub_f32 v81, 0, v4
    v_mfma_f32_16x16x32_bf16 v[212:215], v[56:59], a[172:175], v[212:215]
    v_sub_f32 v82, 0, v4
    v_sub_f32 v83, 0, v4
    v_exp_f32 v112, v112
    v_exp_f32 v113, v113
    v_mfma_f32_16x16x32_bf16 v[216:219], v[52:55], a[176:179], 0
    v_exp_f32 v114, v114
    v_cvt_pk_bf16_f32 v60, v112, v113
    v_exp_f32 v115, v115
    v_exp_f32 v116, v116
    v_mfma_f32_16x16x32_bf16 v[216:219], v[56:59], a[180:183], v[216:219]
    v_cvt_pk_bf16_f32 v61, v114, v115
    v_exp_f32 v117, v117
    v_exp_f32 v118, v118
    v_cvt_pk_bf16_f32 v62, v116, v117
    v_mfma_f32_16x16x32_bf16 v[220:223], v[52:55], a[184:187], 0
    v_exp_f32 v119, v119
    v_exp_f32 v120, v120
    v_cvt_pk_bf16_f32 v63, v118, v119
    v_exp_f32 v121, v121
    v_mfma_f32_16x16x32_bf16 v[220:223], v[56:59], a[188:191], v[220:223]
    v_exp_f32 v122, v122
    v_cvt_pk_bf16_f32 v64, v120, v121
    v_exp_f32 v123, v123
    s_nop 0
    v_cvt_pk_bf16_f32 v65, v122, v123
    s_add_u32 s33, s33, 0x1000
    s_or_b32 s33, s33, 0x18000
    s_xor_b32 s43, s33, s46
    s_xor_b32 s45, s43, 0x800
    s_waitcnt vmcnt(8)
    s_barrier
    s_waitcnt lgkmcnt(8)
    s_branch L_mid
.p2align 12
L_loop:
    v_mfma_f32_16x16x32_bf16 v[148:151], v[52:55], a[232:235], v[148:151]
    v_exp_f32 v121, v121
    v_mfma_f32_16x16x32_bf16 v[148:151], v[56:59], a[236:239], v[148:151]
    v_cvt_pk_bf16_f32 v64, v120, v121
    v_mfma_f32_16x16x32_bf16 v[152:155], v[52:55], a[240:243], v[152:155]
    v_exp_f32 v122, v122
    v_mfma_f32_16x16x32_bf16 v[152:155], v[56:59], a[244:247], v[152:155]
    s_waitcnt lgkmcnt(0)
    v_mfma_f32_16x16x32_bf16 v[156:159], v[52:55], a[248:251], v[156:159]
    s_xor_b32 s41, s41, 0x8000
    v_exp_f32 v123, v123
    v_mfma_f32_16x16x32_bf16 v[156:159], v[56:59], a[252:255], v[156:159]
    v_cvt_pk_bf16_f32 v65, v122, v123
    v_mfma_f32_16x16x32_bf16 v[96:99], a[64:67], a[32:35], v[76:79]
    s_add_u32 m0, s41, 0
    v_exp_f32 v124, v124
    v_mfma_f32_16x16x32_bf16 v[96:99], a[68:71], a[36:39], v[96:99]
    buffer_load_dwordx4 v28, s[24:27], s43 offen nt lds
    v_mfma_f32_16x16x32_bf16 v[96:99], a[72:75], a[40:43], v[96:99]
    v_exp_f32 v125, v125
    v_mfma_f32_16x16x32_bf16 v[96:99], a[76:79], a[44:47], v[96:99]
    v_cvt_pk_bf16_f32 v66, v124, v125
    v_mfma_f32_16x16x32_bf16 v[100:103], a[92:95], a[44:47], v[76:79]
    v_exp_f32 v126, v126
    v_mfma_f32_16x16x32_bf16 v[100:103], a[88:91], a[40:43], v[100:103]
    v_mfma_f32_16x16x32_bf16 v[100:103], a[84:87], a[36:39], v[100:103]
    v_exp_f32 v127, v127
    v_mfma_f32_16x16x32_bf16 v[100:103], a[80:83], a[32:35], v[100:103]
    v_cvt_pk_bf16_f32 v67, v126, v127
    v_mfma_f32_16x16x32_bf16 v[104:107], a[96:99], a[32:35], v[76:79]
    v_exp_f32 v96, v96
    v_mfma_f32_16x16x32_bf16 v[104:107], a[100:103], a[36:39], v[104:107]
    v_mfma_f32_16x16x32_bf16 v[104:107], a[104:107], a[40:43], v[104:107]
    v_exp_f32 v97, v97
    v_mfma_f32_16x16x32_bf16 v[104:107], a[108:111], a[44:47], v[104:107]
    v_cvt_pk_bf16_f32 v52, v96, v97
    v_mfma_f32_16x16x32_bf16 v[108:111], a[124:127], a[44:47], v[76:79]
    v_exp_f32 v98, v98
    v_mfma_f32_16x16x32_bf16 v[108:111], a[120:123], a[40:43], v[108:111]
    v_mfma_f32_16x16x32_bf16 v[108:111], a[116:119], a[36:39], v[108:111]
    v_exp_f32 v99, v99
    v_mfma_f32_16x16x32_bf16 v[108:111], a[112:115], a[32:35], v[108:111]
    v_cvt_pk_bf16_f32 v53, v98, v99
    v_mfma_f32_16x16x32_bf16 v[160:163], v[60:63], a[192:195], v[160:163]
    v_exp_f32 v100, v100
    v_mfma_f32_16x16x32_bf16 v[160:163], v[64:67], a[196:199], v[160:163]
    buffer_load_dwordx4 v29, s[24:27], s43 offen offset:1024 nt lds
    v_mfma_f32_16x16x32_bf16 v[164:167], v[60:63], a[200:203], v[164:167]
    v_exp_f32 v101, v101
    v_mfma_f32_16x16x32_bf16 v[164:167], v[64:67], a[204:207], v[164:167]
    v_cvt_pk_bf16_f32 v54, v100, v101
    v_mfma_f32_16x16x32_bf16 v[168:171], v[60:63], a[208:211], v[168:171]
    v_exp_f32 v102, v102
    v_mfma_f32_16x16x32_bf16 v[168:171], v[64:67], a[212:215], v[168:171]
    v_mfma_f32_16x16x32_bf16 v[172:175], v[60:63], a[216:219], v[172:175]
    v_exp_f32 v103, v103
    v_mfma_f32_16x16x32_bf16 v[172:175], v[64:67], a[220:223], v[172:175]
    v_cvt_pk_bf16_f32 v55, v102, v103
    v_mfma_f32_16x16x32_bf16 v[176:179], v[60:63], a[224:227], v[176:179]
    v_exp_f32 v104, v104
    v_mfma_f32_16x16x32_bf16 v[176:179], v[64:67], a[228:231], v[176:179]
    v_mfma_f32_16x16x32_bf16 v[180:183], v[60:63], a[232:235], v[180:183]
    v_exp_f32 v105, v105
    v_mfma_f32_16x16x32_bf16 v[180:183], v[64:67], a[236:239], v[180:183]
    v_cvt_pk_bf16_f32 v56, v104, v105
    v_mfma_f32_16x16x32_bf16 v[184:187], v[60:63], a[240:243], v[184:187]
    v_exp_f32 v106, v106
    v_mfma_f32_16x16x32_bf16 v[184:187], v[64:67], a[244:247], v[184:187]
    v_mfma_f32_16x16x32_bf16 v[188:191], v[60:63], a[248:251], v[188:191]
    v_exp_f32 v107, v107
    v_mfma_f32_16x16x32_bf16 v[188:191], v[64:67], a[252:255], v[188:191]
    v_cvt_pk_bf16_f32 v57, v106, v107
    v_mfma_f32_16x16x32_bf16 v[112:115], a[64:67], a[48:51], v[80:83]
    s_add_u32 m0, s41, 8192
    v_exp_f32 v108, v108
    v_mfma_f32_16x16x32_bf16 v[112:115], a[68:71], a[52:55], v[112:115]
    buffer_load_dwordx4 v28, s[24:27], s45 offen nt lds
    v_mfma_f32_16x16x32_bf16 v[112:115], a[72:75], a[56:59], v[112:115]
    v_exp_f32 v109, v109
    v_mfma_f32_16x16x32_bf16 v[112:115], a[76:79], a[60:63], v[112:115]
    s_waitcnt vmcnt(7)
    v_cvt_pk_bf16_f32 v58, v108, v109
    v_smfmac_f32_16x16x64_bf16 v[48:51], v[20:23], v[60:67], v24
    s_barrier
    v_mfma_f32_16x16x32_bf16 v[116:119], a[92:95], a[60:63], v[80:83]
    v_exp_f32 v110, v110
    v_mfma_f32_16x16x32_bf16 v[116:119], a[88:91], a[56:59], v[116:119]
    ds_read_b128 a[64:67], v32 offset:16384
    v_mfma_f32_16x16x32_bf16 v[116:119], a[84:87], a[52:55], v[116:119]
    v_exp_f32 v111, v111
    v_mfma_f32_16x16x32_bf16 v[116:119], a[80:83], a[48:51], v[116:119]
    ds_read_b128 a[68:71], v33 offset:16384
    v_cvt_pk_bf16_f32 v59, v110, v111
    v_mfma_f32_16x16x32_bf16 v[120:123], a[96:99], a[48:51], v[80:83]
    v_exp_f32 v112, v112
    v_mfma_f32_16x16x32_bf16 v[120:123], a[100:103], a[52:55], v[120:123]
    ds_read_b128 a[72:75], v34 offset:16384
    v_mfma_f32_16x16x32_bf16 v[120:123], a[104:107], a[56:59], v[120:123]
    v_exp_f32 v113, v113
    v_mfma_f32_16x16x32_bf16 v[120:123], a[108:111], a[60:63], v[120:123]
    ds_read_b128 a[76:79], v35 offset:16384
    v_cvt_pk_bf16_f32 v60, v112, v113
    v_mfma_f32_16x16x32_bf16 v[124:127], a[124:127], a[60:63], v[80:83]
    v_exp_f32 v114, v114
    v_mfma_f32_16x16x32_bf16 v[124:127], a[120:123], a[56:59], v[124:127]
    ds_read_b128 a[92:95], v35 offset:20480
    v_mfma_f32_16x16x32_bf16 v[124:127], a[116:119], a[52:55], v[124:127]
    v_exp_f32 v115, v115
    v_mfma_f32_16x16x32_bf16 v[124:127], a[112:115], a[48:51], v[124:127]
    ds_read_b128 a[88:91], v34 offset:20480
    v_cvt_pk_bf16_f32 v61, v114, v115
    v_smfmac_f32_16x16x64_bf16 v[84:87], v[20:23], v[52:59], v24
    v_mfma_f32_16x16x32_bf16 v[192:195], v[52:55], a[192:195], v[192:195]
    v_exp_f32 v116, v116
    v_mfma_f32_16x16x32_bf16 v[192:195], v[56:59], a[196:199], v[192:195]
    buffer_load_dwordx4 v29, s[24:27], s45 offen offset:1024 nt lds
    v_mfma_f32_16x16x32_bf16 v[196:199], v[52:55], a[200:203], v[196:199]
    v_exp_f32 v117, v117
    v_mfma_f32_16x16x32_bf16 v[196:199], v[56:59], a[204:207], v[196:199]
    ds_read_b128 a[84:87], v33 offset:20480
    v_cvt_pk_bf16_f32 v62, v116, v117
    v_mfma_f32_16x16x32_bf16 v[200:203], v[52:55], a[208:211], v[200:203]
    s_add_u32 s33, s33, 0x1000
    v_exp_f32 v118, v118
    v_mfma_f32_16x16x32_bf16 v[200:203], v[56:59], a[212:215], v[200:203]
    ds_read_b128 a[80:83], v32 offset:20480
    ds_read_b128 a[96:99], v32 offset:24576
    v_mfma_f32_16x16x32_bf16 v[204:207], v[52:55], a[216:219], v[204:207]
    s_or_b32 s33, s33, 0x18000
    v_exp_f32 v119, v119
    v_mfma_f32_16x16x32_bf16 v[204:207], v[56:59], a[220:223], v[204:207]
    ds_read_b128 a[100:103], v33 offset:24576
    v_cvt_pk_bf16_f32 v63, v118, v119
    v_mfma_f32_16x16x32_bf16 v[208:211], v[52:55], a[224:227], v[208:211]
    s_xor_b32 s42, s33, s46
    v_exp_f32 v120, v120
    v_mfma_f32_16x16x32_bf16 v[208:211], v[56:59], a[228:231], v[208:211]
    ds_read_b128 a[104:107], v34 offset:24576
    ds_read_b128 a[108:111], v35 offset:24576
    v_mfma_f32_16x16x32_bf16 v[212:215], v[52:55], a[232:235], v[212:215]
    s_xor_b32 s44, s42, 0x800
    v_exp_f32 v121, v121
    v_mfma_f32_16x16x32_bf16 v[212:215], v[56:59], a[236:239], v[212:215]
    ds_read_b128 a[124:127], v35 offset:28672
    v_cvt_pk_bf16_f32 v64, v120, v121
    v_mfma_f32_16x16x32_bf16 v[216:219], v[52:55], a[240:243], v[216:219]
    v_exp_f32 v122, v122
    v_mfma_f32_16x16x32_bf16 v[216:219], v[56:59], a[244:247], v[216:219]
    ds_read_b128 a[120:123], v34 offset:28672
    ds_read_b128 a[116:119], v33 offset:28672
    v_mfma_f32_16x16x32_bf16 v[220:223], v[52:55], a[248:251], v[220:223]
    v_exp_f32 v123, v123
    v_mfma_f32_16x16x32_bf16 v[220:223], v[56:59], a[252:255], v[220:223]
    s_waitcnt lgkmcnt(7)
    ds_read_b128 a[112:115], v32 offset:28672
    v_cvt_pk_bf16_f32 v65, v122, v123
    v_mfma_f32_16x16x32_bf16 v[96:99], a[64:67], a[0:3], v[68:71]
    s_add_u32 m0, s40, 16384
    v_exp_f32 v124, v124
    v_mfma_f32_16x16x32_bf16 v[96:99], a[68:71], a[4:7], v[96:99]
    buffer_load_dwordx4 v26, s[20:23], s42 offen nt lds
    v_mfma_f32_16x16x32_bf16 v[96:99], a[72:75], a[8:11], v[96:99]
    v_exp_f32 v125, v125
    v_mfma_f32_16x16x32_bf16 v[96:99], a[76:79], a[12:15], v[96:99]
    ds_read_b64_tr_b16 a[128:129], v36 offset:16384
    v_cvt_pk_bf16_f32 v66, v124, v125
    v_mfma_f32_16x16x32_bf16 v[100:103], a[92:95], a[12:15], v[68:71]
    v_exp_f32 v126, v126
    v_mfma_f32_16x16x32_bf16 v[100:103], a[88:91], a[8:11], v[100:103]
    ds_read_b64_tr_b16 a[130:131], v36 offset:20480
    ds_read_b64_tr_b16 a[132:133], v36 offset:24576
    v_mfma_f32_16x16x32_bf16 v[100:103], a[84:87], a[4:7], v[100:103]
    v_exp_f32 v127, v127
    v_mfma_f32_16x16x32_bf16 v[100:103], a[80:83], a[0:3], v[100:103]
    s_waitcnt lgkmcnt(7)
    ds_read_b64_tr_b16 a[134:135], v36 offset:28672
    v_cvt_pk_bf16_f32 v67, v126, v127
    v_mfma_f32_16x16x32_bf16 v[104:107], a[96:99], a[0:3], v[68:71]
    v_exp_f32 v96, v96
    v_mfma_f32_16x16x32_bf16 v[104:107], a[100:103], a[4:7], v[104:107]
    ds_read_b64_tr_b16 a[136:137], v37 offset:16384
    ds_read_b64_tr_b16 a[138:139], v37 offset:20480
    v_mfma_f32_16x16x32_bf16 v[104:107], a[104:107], a[8:11], v[104:107]
    v_exp_f32 v97, v97
    v_mfma_f32_16x16x32_bf16 v[104:107], a[108:111], a[12:15], v[104:107]
    s_waitcnt lgkmcnt(6)
    ds_read_b64_tr_b16 a[140:141], v37 offset:24576
    v_cvt_pk_bf16_f32 v52, v96, v97
    v_smfmac_f32_16x16x64_bf16 v[88:91], v[20:23], v[60:67], v24
    v_mfma_f32_16x16x32_bf16 v[108:111], a[124:127], a[12:15], v[68:71]
    v_exp_f32 v98, v98
    v_mfma_f32_16x16x32_bf16 v[108:111], a[120:123], a[8:11], v[108:111]
    ds_read_b64_tr_b16 a[142:143], v37 offset:28672
    ds_read_b64_tr_b16 a[144:145], v38 offset:16384
    v_mfma_f32_16x16x32_bf16 v[108:111], a[116:119], a[4:7], v[108:111]
    v_exp_f32 v99, v99
    v_mfma_f32_16x16x32_bf16 v[108:111], a[112:115], a[0:3], v[108:111]
    ds_read_b64_tr_b16 a[146:147], v38 offset:20480
    v_cvt_pk_bf16_f32 v53, v98, v99
    v_mfma_f32_16x16x32_bf16 v[224:227], v[60:63], a[192:195], v[224:227]
    v_exp_f32 v100, v100
    v_mfma_f32_16x16x32_bf16 v[224:227], v[64:67], a[196:199], v[224:227]
    buffer_load_dwordx4 v27, s[20:23], s42 offen offset:1024 nt lds
    v_mfma_f32_16x16x32_bf16 v[228:231], v[60:63], a[200:203], v[228:231]
    v_exp_f32 v101, v101
    v_mfma_f32_16x16x32_bf16 v[228:231], v[64:67], a[204:207], v[228:231]
    ds_read_b64_tr_b16 a[148:149], v38 offset:24576
    v_cvt_pk_bf16_f32 v54, v100, v101
    v_mfma_f32_16x16x32_bf16 v[232:235], v[60:63], a[208:211], v[232:235]
    v_exp_f32 v102, v102
    v_mfma_f32_16x16x32_bf16 v[232:235], v[64:67], a[212:215], v[232:235]
    ds_read_b64_tr_b16 a[150:151], v38 offset:28672
    ds_read_b64_tr_b16 a[152:153], v39 offset:16384
    v_mfma_f32_16x16x32_bf16 v[236:239], v[60:63], a[216:219], v[236:239]
    v_exp_f32 v103, v103
    v_mfma_f32_16x16x32_bf16 v[236:239], v[64:67], a[220:223], v[236:239]
    ds_read_b64_tr_b16 a[154:155], v39 offset:20480
    v_cvt_pk_bf16_f32 v55, v102, v103
    v_mfma_f32_16x16x32_bf16 v[240:243], v[60:63], a[224:227], v[240:243]
    v_exp_f32 v104, v104
    v_mfma_f32_16x16x32_bf16 v[240:243], v[64:67], a[228:231], v[240:243]
    ds_read_b64_tr_b16 a[156:157], v39 offset:24576
    ds_read_b64_tr_b16 a[158:159], v39 offset:28672
    v_mfma_f32_16x16x32_bf16 v[244:247], v[60:63], a[232:235], v[244:247]
    v_exp_f32 v105, v105
    v_mfma_f32_16x16x32_bf16 v[244:247], v[64:67], a[236:239], v[244:247]
    ds_read_b64_tr_b16 a[160:161], v40 offset:16384
    v_cvt_pk_bf16_f32 v56, v104, v105
    v_mfma_f32_16x16x32_bf16 v[248:251], v[60:63], a[240:243], v[248:251]
    v_exp_f32 v106, v106
    v_mfma_f32_16x16x32_bf16 v[248:251], v[64:67], a[244:247], v[248:251]
    ds_read_b64_tr_b16 a[162:163], v40 offset:20480
    ds_read_b64_tr_b16 a[164:165], v40 offset:24576
    v_mfma_f32_16x16x32_bf16 v[252:255], v[60:63], a[248:251], v[252:255]
    v_exp_f32 v107, v107
    v_mfma_f32_16x16x32_bf16 v[252:255], v[64:67], a[252:255], v[252:255]
    ds_read_b64_tr_b16 a[166:167], v40 offset:28672
    v_cvt_pk_bf16_f32 v57, v106, v107
    v_mfma_f32_16x16x32_bf16 v[112:115], a[64:67], a[16:19], v[72:75]
    s_add_u32 m0, s40, 24576
    v_exp_f32 v108, v108
    v_mfma_f32_16x16x32_bf16 v[112:115], a[68:71], a[20:23], v[112:115]
    buffer_load_dwordx4 v26, s[20:23], s44 offen nt lds
    v_mfma_f32_16x16x32_bf16 v[112:115], a[72:75], a[24:27], v[112:115]
    v_exp_f32 v109, v109
    v_mfma_f32_16x16x32_bf16 v[112:115], a[76:79], a[28:31], v[112:115]
    ds_read_b64_tr_b16 a[168:169], v41 offset:16384
    v_cvt_pk_bf16_f32 v58, v108, v109
    v_mfma_f32_16x16x32_bf16 v[116:119], a[92:95], a[28:31], v[72:75]
    v_exp_f32 v110, v110
    v_mfma_f32_16x16x32_bf16 v[116:119], a[88:91], a[24:27], v[116:119]
    ds_read_b64_tr_b16 a[170:171], v41 offset:20480
    ds_read_b64_tr_b16 a[172:173], v41 offset:24576
    v_mfma_f32_16x16x32_bf16 v[116:119], a[84:87], a[20:23], v[116:119]
    v_exp_f32 v111, v111
    v_mfma_f32_16x16x32_bf16 v[116:119], a[80:83], a[16:19], v[116:119]
    ds_read_b64_tr_b16 a[174:175], v41 offset:28672
    v_cvt_pk_bf16_f32 v59, v110, v111
    v_mfma_f32_16x16x32_bf16 v[120:123], a[96:99], a[16:19], v[72:75]
    v_exp_f32 v112, v112
    v_mfma_f32_16x16x32_bf16 v[120:123], a[100:103], a[20:23], v[120:123]
    ds_read_b64_tr_b16 a[176:177], v42 offset:16384
    v_mfma_f32_16x16x32_bf16 v[120:123], a[104:107], a[24:27], v[120:123]
    v_exp_f32 v113, v113
    v_mfma_f32_16x16x32_bf16 v[120:123], a[108:111], a[28:31], v[120:123]
    ds_read_b64_tr_b16 a[178:179], v42 offset:20480
    v_cvt_pk_bf16_f32 v60, v112, v113
    v_mfma_f32_16x16x32_bf16 v[124:127], a[124:127], a[28:31], v[72:75]
    v_exp_f32 v114, v114
    v_mfma_f32_16x16x32_bf16 v[124:127], a[120:123], a[24:27], v[124:127]
    ds_read_b64_tr_b16 a[180:181], v42 offset:24576
    v_mfma_f32_16x16x32_bf16 v[124:127], a[116:119], a[20:23], v[124:127]
    v_exp_f32 v115, v115
    v_mfma_f32_16x16x32_bf16 v[124:127], a[112:115], a[16:19], v[124:127]
    s_waitcnt lgkmcnt(14)
    ds_read_b64_tr_b16 a[182:183], v42 offset:28672
    v_cvt_pk_bf16_f32 v61, v114, v115
    v_smfmac_f32_16x16x64_bf16 v[44:47], v[20:23], v[52:59], v24
    v_mfma_f32_16x16x32_bf16 v[128:131], v[52:55], a[128:131], v[128:131]
    v_exp_f32 v116, v116
    v_mfma_f32_16x16x32_bf16 v[128:131], v[56:59], a[132:135], v[128:131]
    buffer_load_dwordx4 v27, s[20:23], s44 offen offset:1024 nt lds
    v_mfma_f32_16x16x32_bf16 v[132:135], v[52:55], a[136:139], v[132:135]
    v_exp_f32 v117, v117
    v_mfma_f32_16x16x32_bf16 v[132:135], v[56:59], a[140:143], v[132:135]
    ds_read_b64_tr_b16 a[184:185], v43 offset:16384
    v_cvt_pk_bf16_f32 v62, v116, v117
    v_mfma_f32_16x16x32_bf16 v[136:139], v[52:55], a[144:147], v[136:139]
    v_exp_f32 v118, v118
    v_mfma_f32_16x16x32_bf16 v[136:139], v[56:59], a[148:151], v[136:139]
    s_waitcnt lgkmcnt(9)
    ds_read_b64_tr_b16 a[186:187], v43 offset:20480
    v_mfma_f32_16x16x32_bf16 v[140:143], v[52:55], a[152:155], v[140:143]
    v_exp_f32 v119, v119
    v_mfma_f32_16x16x32_bf16 v[140:143], v[56:59], a[156:159], v[140:143]
    ds_read_b64_tr_b16 a[188:189], v43 offset:24576
    v_cvt_pk_bf16_f32 v63, v118, v119
    v_mfma_f32_16x16x32_bf16 v[144:147], v[52:55], a[160:163], v[144:147]
    v_exp_f32 v120, v120
    v_mfma_f32_16x16x32_bf16 v[144:147], v[56:59], a[164:167], v[144:147]
    s_waitcnt lgkmcnt(3)
    ds_read_b64_tr_b16 a[190:191], v43 offset:28672
    v_mfma_f32_16x16x32_bf16 v[148:151], v[52:55], a[168:171], v[148:151]
    v_exp_f32 v121, v121
    v_mfma_f32_16x16x32_bf16 v[148:151], v[56:59], a[172:175], v[148:151]
    v_cvt_pk_bf16_f32 v64, v120, v121
    v_xor_b32 v32, 0x8000, v32
    v_mfma_f32_16x16x32_bf16 v[152:155], v[52:55], a[176:179], v[152:155]
    v_exp_f32 v122, v122
    v_mfma_f32_16x16x32_bf16 v[152:155], v[56:59], a[180:183], v[152:155]
    s_waitcnt lgkmcnt(0)
    v_xor_b32 v33, 0x8000, v33
    v_xor_b32 v34, 0x8000, v34
    v_mfma_f32_16x16x32_bf16 v[156:159], v[52:55], a[184:187], v[156:159]
    v_exp_f32 v123, v123
    v_mfma_f32_16x16x32_bf16 v[156:159], v[56:59], a[188:191], v[156:159]
    v_cvt_pk_bf16_f32 v65, v122, v123
    v_xor_b32 v35, 0x8000, v35
    v_mfma_f32_16x16x32_bf16 v[96:99], a[64:67], a[32:35], v[76:79]
    s_add_u32 m0, s41, 16384
    v_exp_f32 v124, v124
    v_mfma_f32_16x16x32_bf16 v[96:99], a[68:71], a[36:39], v[96:99]
    buffer_load_dwordx4 v28, s[24:27], s42 offen nt lds
    v_mfma_f32_16x16x32_bf16 v[96:99], a[72:75], a[40:43], v[96:99]
    v_exp_f32 v125, v125
    v_mfma_f32_16x16x32_bf16 v[96:99], a[76:79], a[44:47], v[96:99]
    v_cvt_pk_bf16_f32 v66, v124, v125
    v_xor_b32 v36, 0x8000, v36
    v_mfma_f32_16x16x32_bf16 v[100:103], a[92:95], a[44:47], v[76:79]
    v_exp_f32 v126, v126
    v_mfma_f32_16x16x32_bf16 v[100:103], a[88:91], a[40:43], v[100:103]
    v_xor_b32 v37, 0x8000, v37
    v_xor_b32 v38, 0x8000, v38
    v_mfma_f32_16x16x32_bf16 v[100:103], a[84:87], a[36:39], v[100:103]
    v_exp_f32 v127, v127
    v_mfma_f32_16x16x32_bf16 v[100:103], a[80:83], a[32:35], v[100:103]
    v_cvt_pk_bf16_f32 v67, v126, v127
    v_xor_b32 v39, 0x8000, v39
    v_mfma_f32_16x16x32_bf16 v[104:107], a[96:99], a[32:35], v[76:79]
    v_exp_f32 v96, v96
    v_mfma_f32_16x16x32_bf16 v[104:107], a[100:103], a[36:39], v[104:107]
    v_xor_b32 v40, 0x8000, v40
    v_xor_b32 v41, 0x8000, v41
    v_mfma_f32_16x16x32_bf16 v[104:107], a[104:107], a[40:43], v[104:107]
    v_exp_f32 v97, v97
    v_mfma_f32_16x16x32_bf16 v[104:107], a[108:111], a[44:47], v[104:107]
    v_cvt_pk_bf16_f32 v52, v96, v97
    v_xor_b32 v42, 0x8000, v42
    v_mfma_f32_16x16x32_bf16 v[108:111], a[124:127], a[44:47], v[76:79]
    v_exp_f32 v98, v98
    v_mfma_f32_16x16x32_bf16 v[108:111], a[120:123], a[40:43], v[108:111]
    v_xor_b32 v43, 0x8000, v43
    v_mfma_f32_16x16x32_bf16 v[108:111], a[116:119], a[36:39], v[108:111]
    v_exp_f32 v99, v99
    v_mfma_f32_16x16x32_bf16 v[108:111], a[112:115], a[32:35], v[108:111]
    v_cvt_pk_bf16_f32 v53, v98, v99
    v_mfma_f32_16x16x32_bf16 v[160:163], v[60:63], a[128:131], v[160:163]
    v_exp_f32 v100, v100
    v_mfma_f32_16x16x32_bf16 v[160:163], v[64:67], a[132:135], v[160:163]
    buffer_load_dwordx4 v29, s[24:27], s42 offen offset:1024 nt lds
    v_mfma_f32_16x16x32_bf16 v[164:167], v[60:63], a[136:139], v[164:167]
    v_exp_f32 v101, v101
    v_mfma_f32_16x16x32_bf16 v[164:167], v[64:67], a[140:143], v[164:167]
    v_cvt_pk_bf16_f32 v54, v100, v101
    v_mfma_f32_16x16x32_bf16 v[168:171], v[60:63], a[144:147], v[168:171]
    v_exp_f32 v102, v102
    v_mfma_f32_16x16x32_bf16 v[168:171], v[64:67], a[148:151], v[168:171]
    v_mfma_f32_16x16x32_bf16 v[172:175], v[60:63], a[152:155], v[172:175]
    v_exp_f32 v103, v103
    v_mfma_f32_16x16x32_bf16 v[172:175], v[64:67], a[156:159], v[172:175]
    v_cvt_pk_bf16_f32 v55, v102, v103
    v_mfma_f32_16x16x32_bf16 v[176:179], v[60:63], a[160:163], v[176:179]
    v_exp_f32 v104, v104
    v_mfma_f32_16x16x32_bf16 v[176:179], v[64:67], a[164:167], v[176:179]
    v_mfma_f32_16x16x32_bf16 v[180:183], v[60:63], a[168:171], v[180:183]
    v_exp_f32 v105, v105
    v_mfma_f32_16x16x32_bf16 v[180:183], v[64:67], a[172:175], v[180:183]
    v_cvt_pk_bf16_f32 v56, v104, v105
    v_mfma_f32_16x16x32_bf16 v[184:187], v[60:63], a[176:179], v[184:187]
    v_exp_f32 v106, v106
    v_mfma_f32_16x16x32_bf16 v[184:187], v[64:67], a[180:183], v[184:187]
    v_mfma_f32_16x16x32_bf16 v[188:191], v[60:63], a[184:187], v[188:191]
    v_exp_f32 v107, v107
    v_mfma_f32_16x16x32_bf16 v[188:191], v[64:67], a[188:191], v[188:191]
    v_cvt_pk_bf16_f32 v57, v106, v107
    v_mfma_f32_16x16x32_bf16 v[112:115], a[64:67], a[48:51], v[80:83]
    s_add_u32 m0, s41, 24576
    v_exp_f32 v108, v108
    v_mfma_f32_16x16x32_bf16 v[112:115], a[68:71], a[52:55], v[112:115]
    buffer_load_dwordx4 v28, s[24:27], s44 offen nt lds
    v_mfma_f32_16x16x32_bf16 v[112:115], a[72:75], a[56:59], v[112:115]
    v_exp_f32 v109, v109
    v_mfma_f32_16x16x32_bf16 v[112:115], a[76:79], a[60:63], v[112:115]
    s_waitcnt vmcnt(7)
    v_cvt_pk_bf16_f32 v58, v108, v109
    v_smfmac_f32_16x16x64_bf16 v[48:51], v[20:23], v[60:67], v24
    s_barrier
    v_mfma_f32_16x16x32_bf16 v[116:119], a[92:95], a[60:63], v[80:83]
    v_exp_f32 v110, v110
    v_mfma_f32_16x16x32_bf16 v[116:119], a[88:91], a[56:59], v[116:119]
    ds_read_b128 a[64:67], v32 offset:0
    v_mfma_f32_16x16x32_bf16 v[116:119], a[84:87], a[52:55], v[116:119]
    v_exp_f32 v111, v111
    v_mfma_f32_16x16x32_bf16 v[116:119], a[80:83], a[48:51], v[116:119]
    ds_read_b128 a[68:71], v33 offset:0
    v_cvt_pk_bf16_f32 v59, v110, v111
    v_mfma_f32_16x16x32_bf16 v[120:123], a[96:99], a[48:51], v[80:83]
    v_exp_f32 v112, v112
    v_mfma_f32_16x16x32_bf16 v[120:123], a[100:103], a[52:55], v[120:123]
    ds_read_b128 a[72:75], v34 offset:0
    v_mfma_f32_16x16x32_bf16 v[120:123], a[104:107], a[56:59], v[120:123]
    v_exp_f32 v113, v113
    v_mfma_f32_16x16x32_bf16 v[120:123], a[108:111], a[60:63], v[120:123]
    ds_read_b128 a[76:79], v35 offset:0
    v_cvt_pk_bf16_f32 v60, v112, v113
    v_mfma_f32_16x16x32_bf16 v[124:127], a[124:127], a[60:63], v[80:83]
    v_exp_f32 v114, v114
    v_mfma_f32_16x16x32_bf16 v[124:127], a[120:123], a[56:59], v[124:127]
    ds_read_b128 a[92:95], v35 offset:4096
    v_mfma_f32_16x16x32_bf16 v[124:127], a[116:119], a[52:55], v[124:127]
    v_exp_f32 v115, v115
    v_mfma_f32_16x16x32_bf16 v[124:127], a[112:115], a[48:51], v[124:127]
    ds_read_b128 a[88:91], v34 offset:4096
    v_cvt_pk_bf16_f32 v61, v114, v115
    v_smfmac_f32_16x16x64_bf16 v[84:87], v[20:23], v[52:59], v24
    v_mfma_f32_16x16x32_bf16 v[192:195], v[52:55], a[128:131], v[192:195]
    v_exp_f32 v116, v116
    v_mfma_f32_16x16x32_bf16 v[192:195], v[56:59], a[132:135], v[192:195]
    buffer_load_dwordx4 v29, s[24:27], s44 offen offset:1024 nt lds
    v_mfma_f32_16x16x32_bf16 v[196:199], v[52:55], a[136:139], v[196:199]
    v_exp_f32 v117, v117
    v_mfma_f32_16x16x32_bf16 v[196:199], v[56:59], a[140:143], v[196:199]
    ds_read_b128 a[84:87], v33 offset:4096
    v_cvt_pk_bf16_f32 v62, v116, v117
    v_mfma_f32_16x16x32_bf16 v[200:203], v[52:55], a[144:147], v[200:203]
    s_add_u32 s33, s33, 0x1000
    v_exp_f32 v118, v118
    v_mfma_f32_16x16x32_bf16 v[200:203], v[56:59], a[148:151], v[200:203]
    ds_read_b128 a[80:83], v32 offset:4096
    ds_read_b128 a[96:99], v32 offset:8192
    v_mfma_f32_16x16x32_bf16 v[204:207], v[52:55], a[152:155], v[204:207]
    s_or_b32 s33, s33, 0x18000
    v_exp_f32 v119, v119
    v_mfma_f32_16x16x32_bf16 v[204:207], v[56:59], a[156:159], v[204:207]
    ds_read_b128 a[100:103], v33 offset:8192
    v_cvt_pk_bf16_f32 v63, v118, v119
    v_mfma_f32_16x16x32_bf16 v[208:211], v[52:55], a[160:163], v[208:211]
    s_xor_b32 s43, s33, s46
    v_exp_f32 v120, v120
    v_mfma_f32_16x16x32_bf16 v[208:211], v[56:59], a[164:167], v[208:211]
    ds_read_b128 a[104:107], v34 offset:8192
    ds_read_b128 a[108:111], v35 offset:8192
    v_mfma_f32_16x16x32_bf16 v[212:215], v[52:55], a[168:171], v[212:215]
    s_xor_b32 s45, s43, 0x800
    v_exp_f32 v121, v121
    v_mfma_f32_16x16x32_bf16 v[212:215], v[56:59], a[172:175], v[212:215]
    ds_read_b128 a[124:127], v35 offset:12288
    v_cvt_pk_bf16_f32 v64, v120, v121
    v_mfma_f32_16x16x32_bf16 v[216:219], v[52:55], a[176:179], v[216:219]
    v_exp_f32 v122, v122
    v_mfma_f32_16x16x32_bf16 v[216:219], v[56:59], a[180:183], v[216:219]
    ds_read_b128 a[120:123], v34 offset:12288
    ds_read_b128 a[116:119], v33 offset:12288
    v_mfma_f32_16x16x32_bf16 v[220:223], v[52:55], a[184:187], v[220:223]
    v_exp_f32 v123, v123
    v_mfma_f32_16x16x32_bf16 v[220:223], v[56:59], a[188:191], v[220:223]
    s_waitcnt lgkmcnt(7)
    ds_read_b128 a[112:115], v32 offset:12288
    v_cvt_pk_bf16_f32 v65, v122, v123
L_mid:
    v_mfma_f32_16x16x32_bf16 v[96:99], a[64:67], a[0:3], v[68:71]
    s_xor_b32 s40, s40, 0x8000
    s_add_u32 m0, s40, 0
    v_exp_f32 v124, v124
    v_mfma_f32_16x16x32_bf16 v[96:99], a[68:71], a[4:7], v[96:99]
    buffer_load_dwordx4 v26, s[20:23], s43 offen nt lds
    v_mfma_f32_16x16x32_bf16 v[96:99], a[72:75], a[8:11], v[96:99]
    v_exp_f32 v125, v125
    v_mfma_f32_16x16x32_bf16 v[96:99], a[76:79], a[12:15], v[96:99]
    ds_read_b64_tr_b16 a[192:193], v36 offset:0
    v_cvt_pk_bf16_f32 v66, v124, v125
    v_mfma_f32_16x16x32_bf16 v[100:103], a[92:95], a[12:15], v[68:71]
    v_exp_f32 v126, v126
    v_mfma_f32_16x16x32_bf16 v[100:103], a[88:91], a[8:11], v[100:103]
    ds_read_b64_tr_b16 a[194:195], v36 offset:4096
    ds_read_b64_tr_b16 a[196:197], v36 offset:8192
    v_mfma_f32_16x16x32_bf16 v[100:103], a[84:87], a[4:7], v[100:103]
    v_exp_f32 v127, v127
    v_mfma_f32_16x16x32_bf16 v[100:103], a[80:83], a[0:3], v[100:103]
    s_waitcnt lgkmcnt(7)
    ds_read_b64_tr_b16 a[198:199], v36 offset:12288
    v_cvt_pk_bf16_f32 v67, v126, v127
    v_mfma_f32_16x16x32_bf16 v[104:107], a[96:99], a[0:3], v[68:71]
    v_exp_f32 v96, v96
    v_mfma_f32_16x16x32_bf16 v[104:107], a[100:103], a[4:7], v[104:107]
    ds_read_b64_tr_b16 a[200:201], v37 offset:0
    ds_read_b64_tr_b16 a[202:203], v37 offset:4096
    v_mfma_f32_16x16x32_bf16 v[104:107], a[104:107], a[8:11], v[104:107]
    v_exp_f32 v97, v97
    v_mfma_f32_16x16x32_bf16 v[104:107], a[108:111], a[12:15], v[104:107]
    s_waitcnt lgkmcnt(6)
    ds_read_b64_tr_b16 a[204:205], v37 offset:8192
    v_cvt_pk_bf16_f32 v52, v96, v97
    v_smfmac_f32_16x16x64_bf16 v[88:91], v[20:23], v[60:67], v24
    v_mfma_f32_16x16x32_bf16 v[108:111], a[124:127], a[12:15], v[68:71]
    v_exp_f32 v98, v98
    v_mfma_f32_16x16x32_bf16 v[108:111], a[120:123], a[8:11], v[108:111]
    ds_read_b64_tr_b16 a[206:207], v37 offset:12288
    ds_read_b64_tr_b16 a[208:209], v38 offset:0
    v_mfma_f32_16x16x32_bf16 v[108:111], a[116:119], a[4:7], v[108:111]
    v_exp_f32 v99, v99
    v_mfma_f32_16x16x32_bf16 v[108:111], a[112:115], a[0:3], v[108:111]
    ds_read_b64_tr_b16 a[210:211], v38 offset:4096
    v_cvt_pk_bf16_f32 v53, v98, v99
    v_mfma_f32_16x16x32_bf16 v[224:227], v[60:63], a[128:131], v[224:227]
    v_exp_f32 v100, v100
    v_mfma_f32_16x16x32_bf16 v[224:227], v[64:67], a[132:135], v[224:227]
    buffer_load_dwordx4 v27, s[20:23], s43 offen offset:1024 nt lds
    v_mfma_f32_16x16x32_bf16 v[228:231], v[60:63], a[136:139], v[228:231]
    v_exp_f32 v101, v101
    v_mfma_f32_16x16x32_bf16 v[228:231], v[64:67], a[140:143], v[228:231]
    ds_read_b64_tr_b16 a[212:213], v38 offset:8192
    v_cvt_pk_bf16_f32 v54, v100, v101
    v_mfma_f32_16x16x32_bf16 v[232:235], v[60:63], a[144:147], v[232:235]
    v_exp_f32 v102, v102
    v_mfma_f32_16x16x32_bf16 v[232:235], v[64:67], a[148:151], v[232:235]
    ds_read_b64_tr_b16 a[214:215], v38 offset:12288
    ds_read_b64_tr_b16 a[216:217], v39 offset:0
    v_mfma_f32_16x16x32_bf16 v[236:239], v[60:63], a[152:155], v[236:239]
    v_exp_f32 v103, v103
    v_mfma_f32_16x16x32_bf16 v[236:239], v[64:67], a[156:159], v[236:239]
    ds_read_b64_tr_b16 a[218:219], v39 offset:4096
    v_cvt_pk_bf16_f32 v55, v102, v103
    v_mfma_f32_16x16x32_bf16 v[240:243], v[60:63], a[160:163], v[240:243]
    v_exp_f32 v104, v104
    v_mfma_f32_16x16x32_bf16 v[240:243], v[64:67], a[164:167], v[240:243]
    ds_read_b64_tr_b16 a[220:221], v39 offset:8192
    ds_read_b64_tr_b16 a[222:223], v39 offset:12288
    v_mfma_f32_16x16x32_bf16 v[244:247], v[60:63], a[168:171], v[244:247]
    v_exp_f32 v105, v105
    v_mfma_f32_16x16x32_bf16 v[244:247], v[64:67], a[172:175], v[244:247]
    ds_read_b64_tr_b16 a[224:225], v40 offset:0
    v_cvt_pk_bf16_f32 v56, v104, v105
    v_mfma_f32_16x16x32_bf16 v[248:251], v[60:63], a[176:179], v[248:251]
    v_exp_f32 v106, v106
    v_mfma_f32_16x16x32_bf16 v[248:251], v[64:67], a[180:183], v[248:251]
    ds_read_b64_tr_b16 a[226:227], v40 offset:4096
    ds_read_b64_tr_b16 a[228:229], v40 offset:8192
    v_mfma_f32_16x16x32_bf16 v[252:255], v[60:63], a[184:187], v[252:255]
    v_exp_f32 v107, v107
    v_mfma_f32_16x16x32_bf16 v[252:255], v[64:67], a[188:191], v[252:255]
    ds_read_b64_tr_b16 a[230:231], v40 offset:12288
    v_cvt_pk_bf16_f32 v57, v106, v107
    v_mfma_f32_16x16x32_bf16 v[112:115], a[64:67], a[16:19], v[72:75]
    s_add_u32 m0, s40, 8192
    v_exp_f32 v108, v108
    v_mfma_f32_16x16x32_bf16 v[112:115], a[68:71], a[20:23], v[112:115]
    buffer_load_dwordx4 v26, s[20:23], s45 offen nt lds
    v_mfma_f32_16x16x32_bf16 v[112:115], a[72:75], a[24:27], v[112:115]
    v_exp_f32 v109, v109
    v_mfma_f32_16x16x32_bf16 v[112:115], a[76:79], a[28:31], v[112:115]
    ds_read_b64_tr_b16 a[232:233], v41 offset:0
    v_cvt_pk_bf16_f32 v58, v108, v109
    v_mfma_f32_16x16x32_bf16 v[116:119], a[92:95], a[28:31], v[72:75]
    v_exp_f32 v110, v110
    v_mfma_f32_16x16x32_bf16 v[116:119], a[88:91], a[24:27], v[116:119]
    ds_read_b64_tr_b16 a[234:235], v41 offset:4096
    ds_read_b64_tr_b16 a[236:237], v41 offset:8192
    v_mfma_f32_16x16x32_bf16 v[116:119], a[84:87], a[20:23], v[116:119]
    v_exp_f32 v111, v111
    v_mfma_f32_16x16x32_bf16 v[116:119], a[80:83], a[16:19], v[116:119]
    ds_read_b64_tr_b16 a[238:239], v41 offset:12288
    v_cvt_pk_bf16_f32 v59, v110, v111
    v_mfma_f32_16x16x32_bf16 v[120:123], a[96:99], a[16:19], v[72:75]
    v_exp_f32 v112, v112
    v_mfma_f32_16x16x32_bf16 v[120:123], a[100:103], a[20:23], v[120:123]
    ds_read_b64_tr_b16 a[240:241], v42 offset:0
    v_mfma_f32_16x16x32_bf16 v[120:123], a[104:107], a[24:27], v[120:123]
    v_exp_f32 v113, v113
    v_mfma_f32_16x16x32_bf16 v[120:123], a[108:111], a[28:31], v[120:123]
    ds_read_b64_tr_b16 a[242:243], v42 offset:4096
    v_cvt_pk_bf16_f32 v60, v112, v113
    v_mfma_f32_16x16x32_bf16 v[124:127], a[124:127], a[28:31], v[72:75]
    v_exp_f32 v114, v114
    v_mfma_f32_16x16x32_bf16 v[124:127], a[120:123], a[24:27], v[124:127]
    ds_read_b64_tr_b16 a[244:245], v42 offset:8192
    v_mfma_f32_16x16x32_bf16 v[124:127], a[116:119], a[20:23], v[124:127]
    v_exp_f32 v115, v115
    v_mfma_f32_16x16x32_bf16 v[124:127], a[112:115], a[16:19], v[124:127]
    s_waitcnt lgkmcnt(14)
    ds_read_b64_tr_b16 a[246:247], v42 offset:12288
    v_cvt_pk_bf16_f32 v61, v114, v115
    v_smfmac_f32_16x16x64_bf16 v[44:47], v[20:23], v[52:59], v24
    v_mfma_f32_16x16x32_bf16 v[128:131], v[52:55], a[192:195], v[128:131]
    v_exp_f32 v116, v116
    v_mfma_f32_16x16x32_bf16 v[128:131], v[56:59], a[196:199], v[128:131]
    buffer_load_dwordx4 v27, s[20:23], s45 offen offset:1024 nt lds
    v_mfma_f32_16x16x32_bf16 v[132:135], v[52:55], a[200:203], v[132:135]
    v_exp_f32 v117, v117
    v_mfma_f32_16x16x32_bf16 v[132:135], v[56:59], a[204:207], v[132:135]
    ds_read_b64_tr_b16 a[248:249], v43 offset:0
    v_cvt_pk_bf16_f32 v62, v116, v117
    v_mfma_f32_16x16x32_bf16 v[136:139], v[52:55], a[208:211], v[136:139]
    s_add_u32 s32, s32, 1
    v_exp_f32 v118, v118
    v_mfma_f32_16x16x32_bf16 v[136:139], v[56:59], a[212:215], v[136:139]
    s_waitcnt lgkmcnt(9)
    ds_read_b64_tr_b16 a[250:251], v43 offset:4096
    v_mfma_f32_16x16x32_bf16 v[140:143], v[52:55], a[216:219], v[140:143]
    s_cmp_lt_u32 s32, 15
    v_exp_f32 v119, v119
    v_mfma_f32_16x16x32_bf16 v[140:143], v[56:59], a[220:223], v[140:143]
    ds_read_b64_tr_b16 a[252:253], v43 offset:8192
    v_cvt_pk_bf16_f32 v63, v118, v119
    v_mfma_f32_16x16x32_bf16 v[144:147], v[52:55], a[224:227], v[144:147]
    v_exp_f32 v120, v120
    v_mfma_f32_16x16x32_bf16 v[144:147], v[56:59], a[228:231], v[144:147]
    s_waitcnt lgkmcnt(3)
    ds_read_b64_tr_b16 a[254:255], v43 offset:12288
    s_cbranch_scc1 L_loop
L_tail:
    v_mfma_f32_16x16x32_bf16 v[148:151], v[52:55], a[232:235], v[148:151]
    s_xor_b32 s41, s41, 0x8000
    v_exp_f32 v121, v121
    v_mfma_f32_16x16x32_bf16 v[148:151], v[56:59], a[236:239], v[148:151]
    v_cvt_pk_bf16_f32 v64, v120, v121
    v_mfma_f32_16x16x32_bf16 v[152:155], v[52:55], a[240:243], v[152:155]
    s_add_u32 m0, s41, 0
    v_exp_f32 v122, v122
    v_mfma_f32_16x16x32_bf16 v[152:155], v[56:59], a[244:247], v[152:155]
    s_waitcnt lgkmcnt(0)
    buffer_load_dwordx4 v28, s[24:27], s43 offen nt lds
    v_mfma_f32_16x16x32_bf16 v[156:159], v[52:55], a[248:251], v[156:159]
    v_exp_f32 v123, v123
    v_mfma_f32_16x16x32_bf16 v[156:159], v[56:59], a[252:255], v[156:159]
    v_cvt_pk_bf16_f32 v65, v122, v123
    v_mfma_f32_16x16x32_bf16 v[96:99], a[64:67], a[32:35], v[76:79]
    v_exp_f32 v124, v124
    v_mfma_f32_16x16x32_bf16 v[96:99], a[68:71], a[36:39], v[96:99]
    v_mfma_f32_16x16x32_bf16 v[96:99], a[72:75], a[40:43], v[96:99]
    v_exp_f32 v125, v125
    v_mfma_f32_16x16x32_bf16 v[96:99], a[76:79], a[44:47], v[96:99]
    v_cvt_pk_bf16_f32 v66, v124, v125
    v_mfma_f32_16x16x32_bf16 v[100:103], a[92:95], a[44:47], v[76:79]
    v_exp_f32 v126, v126
    v_mfma_f32_16x16x32_bf16 v[100:103], a[88:91], a[40:43], v[100:103]
    buffer_load_dwordx4 v29, s[24:27], s43 offen offset:1024 nt lds
    v_mfma_f32_16x16x32_bf16 v[100:103], a[84:87], a[36:39], v[100:103]
    v_exp_f32 v127, v127
    v_mfma_f32_16x16x32_bf16 v[100:103], a[80:83], a[32:35], v[100:103]
    v_cvt_pk_bf16_f32 v67, v126, v127
    v_mfma_f32_16x16x32_bf16 v[104:107], a[96:99], a[32:35], v[76:79]
    v_exp_f32 v96, v96
    v_mfma_f32_16x16x32_bf16 v[104:107], a[100:103], a[36:39], v[104:107]
    v_mfma_f32_16x16x32_bf16 v[104:107], a[104:107], a[40:43], v[104:107]
    v_exp_f32 v97, v97
    v_mfma_f32_16x16x32_bf16 v[104:107], a[108:111], a[44:47], v[104:107]
    v_cvt_pk_bf16_f32 v52, v96, v97
    v_mfma_f32_16x16x32_bf16 v[108:111], a[124:127], a[44:47], v[76:79]
    s_add_u32 m0, s41, 8192
    v_exp_f32 v98, v98
    v_mfma_f32_16x16x32_bf16 v[108:111], a[120:123], a[40:43], v[108:111]
    buffer_load_dwordx4 v28, s[24:27], s45 offen nt lds
    v_mfma_f32_16x16x32_bf16 v[108:111], a[116:119], a[36:39], v[108:111]
    v_exp_f32 v99, v99
    v_mfma_f32_16x16x32_bf16 v[108:111], a[112:115], a[32:35], v[108:111]
    v_cvt_pk_bf16_f32 v53, v98, v99
    v_mfma_f32_16x16x32_bf16 v[160:163], v[60:63], a[192:195], v[160:163]
    v_exp_f32 v100, v100
    v_mfma_f32_16x16x32_bf16 v[160:163], v[64:67], a[196:199], v[160:163]
    v_mfma_f32_16x16x32_bf16 v[164:167], v[60:63], a[200:203], v[164:167]
    v_exp_f32 v101, v101
    v_mfma_f32_16x16x32_bf16 v[164:167], v[64:67], a[204:207], v[164:167]
    v_cvt_pk_bf16_f32 v54, v100, v101
    v_mfma_f32_16x16x32_bf16 v[168:171], v[60:63], a[208:211], v[168:171]
    v_exp_f32 v102, v102
    v_mfma_f32_16x16x32_bf16 v[168:171], v[64:67], a[212:215], v[168:171]
    buffer_load_dwordx4 v29, s[24:27], s45 offen offset:1024 nt lds
    v_mfma_f32_16x16x32_bf16 v[172:175], v[60:63], a[216:219], v[172:175]
    v_exp_f32 v103, v103
    v_mfma_f32_16x16x32_bf16 v[172:175], v[64:67], a[220:223], v[172:175]
    v_cvt_pk_bf16_f32 v55, v102, v103
    v_mfma_f32_16x16x32_bf16 v[176:179], v[60:63], a[224:227], v[176:179]
    v_exp_f32 v104, v104
    v_mfma_f32_16x16x32_bf16 v[176:179], v[64:67], a[228:231], v[176:179]
    v_mfma_f32_16x16x32_bf16 v[180:183], v[60:63], a[232:235], v[180:183]
    v_exp_f32 v105, v105
    v_mfma_f32_16x16x32_bf16 v[180:183], v[64:67], a[236:239], v[180:183]
    v_cvt_pk_bf16_f32 v56, v104, v105
    v_mfma_f32_16x16x32_bf16 v[184:187], v[60:63], a[240:243], v[184:187]
    v_exp_f32 v106, v106
    v_mfma_f32_16x16x32_bf16 v[184:187], v[64:67], a[244:247], v[184:187]
    v_mfma_f32_16x16x32_bf16 v[188:191], v[60:63], a[248:251], v[188:191]
    v_exp_f32 v107, v107
    v_mfma_f32_16x16x32_bf16 v[188:191], v[64:67], a[252:255], v[188:191]
    v_cvt_pk_bf16_f32 v57, v106, v107
    v_mfma_f32_16x16x32_bf16 v[112:115], a[64:67], a[48:51], v[80:83]
    v_exp_f32 v108, v108
    v_mfma_f32_16x16x32_bf16 v[112:115], a[68:71], a[52:55], v[112:115]
    v_mfma_f32_16x16x32_bf16 v[112:115], a[72:75], a[56:59], v[112:115]
    v_exp_f32 v109, v109
    v_mfma_f32_16x16x32_bf16 v[112:115], a[76:79], a[60:63], v[112:115]
    s_waitcnt vmcnt(8)
    v_cvt_pk_bf16_f32 v58, v108, v109
    v_smfmac_f32_16x16x64_bf16 v[48:51], v[20:23], v[60:67], v24
    s_barrier
    v_mfma_f32_16x16x32_bf16 v[116:119], a[92:95], a[60:63], v[80:83]
    v_exp_f32 v110, v110
    v_mfma_f32_16x16x32_bf16 v[116:119], a[88:91], a[56:59], v[116:119]
    ds_read_b128 a[64:67], v32 offset:16384
    v_mfma_f32_16x16x32_bf16 v[116:119], a[84:87], a[52:55], v[116:119]
    v_exp_f32 v111, v111
    v_mfma_f32_16x16x32_bf16 v[116:119], a[80:83], a[48:51], v[116:119]
    ds_read_b128 a[68:71], v33 offset:16384
    v_cvt_pk_bf16_f32 v59, v110, v111
    v_mfma_f32_16x16x32_bf16 v[120:123], a[96:99], a[48:51], v[80:83]
    v_exp_f32 v112, v112
    v_mfma_f32_16x16x32_bf16 v[120:123], a[100:103], a[52:55], v[120:123]
    ds_read_b128 a[72:75], v34 offset:16384
    v_mfma_f32_16x16x32_bf16 v[120:123], a[104:107], a[56:59], v[120:123]
    v_exp_f32 v113, v113
    v_mfma_f32_16x16x32_bf16 v[120:123], a[108:111], a[60:63], v[120:123]
    ds_read_b128 a[76:79], v35 offset:16384
    v_cvt_pk_bf16_f32 v60, v112, v113
    v_mfma_f32_16x16x32_bf16 v[124:127], a[124:127], a[60:63], v[80:83]
    v_exp_f32 v114, v114
    v_mfma_f32_16x16x32_bf16 v[124:127], a[120:123], a[56:59], v[124:127]
    ds_read_b128 a[92:95], v35 offset:20480
    v_mfma_f32_16x16x32_bf16 v[124:127], a[116:119], a[52:55], v[124:127]
    v_exp_f32 v115, v115
    v_mfma_f32_16x16x32_bf16 v[124:127], a[112:115], a[48:51], v[124:127]
    ds_read_b128 a[88:91], v34 offset:20480
    v_cvt_pk_bf16_f32 v61, v114, v115
    v_smfmac_f32_16x16x64_bf16 v[84:87], v[20:23], v[52:59], v24
    v_mfma_f32_16x16x32_bf16 v[192:195], v[52:55], a[192:195], v[192:195]
    v_exp_f32 v116, v116
    v_mfma_f32_16x16x32_bf16 v[192:195], v[56:59], a[196:199], v[192:195]
    v_mfma_f32_16x16x32_bf16 v[196:199], v[52:55], a[200:203], v[196:199]
    v_exp_f32 v117, v117
    v_mfma_f32_16x16x32_bf16 v[196:199], v[56:59], a[204:207], v[196:199]
    ds_read_b128 a[84:87], v33 offset:20480
    v_cvt_pk_bf16_f32 v62, v116, v117
    v_mfma_f32_16x16x32_bf16 v[200:203], v[52:55], a[208:211], v[200:203]
    v_exp_f32 v118, v118
    v_mfma_f32_16x16x32_bf16 v[200:203], v[56:59], a[212:215], v[200:203]
    ds_read_b128 a[80:83], v32 offset:20480
    ds_read_b128 a[96:99], v32 offset:24576
    v_mfma_f32_16x16x32_bf16 v[204:207], v[52:55], a[216:219], v[204:207]
    v_exp_f32 v119, v119
    v_mfma_f32_16x16x32_bf16 v[204:207], v[56:59], a[220:223], v[204:207]
    ds_read_b128 a[100:103], v33 offset:24576
    v_cvt_pk_bf16_f32 v63, v118, v119
    v_mfma_f32_16x16x32_bf16 v[208:211], v[52:55], a[224:227], v[208:211]
    v_exp_f32 v120, v120
    v_mfma_f32_16x16x32_bf16 v[208:211], v[56:59], a[228:231], v[208:211]
    ds_read_b128 a[104:107], v34 offset:24576
    ds_read_b128 a[108:111], v35 offset:24576
    v_mfma_f32_16x16x32_bf16 v[212:215], v[52:55], a[232:235], v[212:215]
    v_exp_f32 v121, v121
    v_mfma_f32_16x16x32_bf16 v[212:215], v[56:59], a[236:239], v[212:215]
    ds_read_b128 a[124:127], v35 offset:28672
    v_cvt_pk_bf16_f32 v64, v120, v121
    v_mfma_f32_16x16x32_bf16 v[216:219], v[52:55], a[240:243], v[216:219]
    v_exp_f32 v122, v122
    v_mfma_f32_16x16x32_bf16 v[216:219], v[56:59], a[244:247], v[216:219]
    ds_read_b128 a[120:123], v34 offset:28672
    ds_read_b128 a[116:119], v33 offset:28672
    v_mfma_f32_16x16x32_bf16 v[220:223], v[52:55], a[248:251], v[220:223]
    v_exp_f32 v123, v123
    v_mfma_f32_16x16x32_bf16 v[220:223], v[56:59], a[252:255], v[220:223]
    s_waitcnt lgkmcnt(7)
    ds_read_b128 a[112:115], v32 offset:28672
    v_cvt_pk_bf16_f32 v65, v122, v123
    v_mfma_f32_16x16x32_bf16 v[96:99], a[64:67], a[0:3], v[68:71]
    v_exp_f32 v124, v124
    v_mfma_f32_16x16x32_bf16 v[96:99], a[68:71], a[4:7], v[96:99]
    ds_read_b64_tr_b16 a[128:129], v36 offset:16384
    ds_read_b64_tr_b16 a[130:131], v36 offset:20480
    v_mfma_f32_16x16x32_bf16 v[96:99], a[72:75], a[8:11], v[96:99]
    v_exp_f32 v125, v125
    v_mfma_f32_16x16x32_bf16 v[96:99], a[76:79], a[12:15], v[96:99]
    ds_read_b64_tr_b16 a[132:133], v36 offset:24576
    v_cvt_pk_bf16_f32 v66, v124, v125
    v_mfma_f32_16x16x32_bf16 v[100:103], a[92:95], a[12:15], v[68:71]
    v_exp_f32 v126, v126
    v_mfma_f32_16x16x32_bf16 v[100:103], a[88:91], a[8:11], v[100:103]
    ds_read_b64_tr_b16 a[134:135], v36 offset:28672
    ds_read_b64_tr_b16 a[136:137], v37 offset:16384
    v_mfma_f32_16x16x32_bf16 v[100:103], a[84:87], a[4:7], v[100:103]
    v_exp_f32 v127, v127
    v_mfma_f32_16x16x32_bf16 v[100:103], a[80:83], a[0:3], v[100:103]
    s_waitcnt lgkmcnt(9)
    ds_read_b64_tr_b16 a[138:139], v37 offset:20480
    v_cvt_pk_bf16_f32 v67, v126, v127
    v_mfma_f32_16x16x32_bf16 v[104:107], a[96:99], a[0:3], v[68:71]
    v_exp_f32 v96, v96
    v_mfma_f32_16x16x32_bf16 v[104:107], a[100:103], a[4:7], v[104:107]
    ds_read_b64_tr_b16 a[140:141], v37 offset:24576
    ds_read_b64_tr_b16 a[142:143], v37 offset:28672
    v_mfma_f32_16x16x32_bf16 v[104:107], a[104:107], a[8:11], v[104:107]
    v_exp_f32 v97, v97
    v_mfma_f32_16x16x32_bf16 v[104:107], a[108:111], a[12:15], v[104:107]
    s_waitcnt lgkmcnt(8)
    ds_read_b64_tr_b16 a[144:145], v38 offset:16384
    v_cvt_pk_bf16_f32 v52, v96, v97
    v_smfmac_f32_16x16x64_bf16 v[88:91], v[20:23], v[60:67], v24
    v_mfma_f32_16x16x32_bf16 v[108:111], a[124:127], a[12:15], v[68:71]
    v_exp_f32 v98, v98
    v_mfma_f32_16x16x32_bf16 v[108:111], a[120:123], a[8:11], v[108:111]
    ds_read_b64_tr_b16 a[146:147], v38 offset:20480
    ds_read_b64_tr_b16 a[148:149], v38 offset:24576
    v_mfma_f32_16x16x32_bf16 v[108:111], a[116:119], a[4:7], v[108:111]
    v_exp_f32 v99, v99
    v_mfma_f32_16x16x32_bf16 v[108:111], a[112:115], a[0:3], v[108:111]
    ds_read_b64_tr_b16 a[150:151], v38 offset:28672
    v_cvt_pk_bf16_f32 v53, v98, v99
    v_mfma_f32_16x16x32_bf16 v[224:227], v[60:63], a[192:195], v[224:227]
    v_exp_f32 v100, v100
    v_mfma_f32_16x16x32_bf16 v[224:227], v[64:67], a[196:199], v[224:227]
    ds_read_b64_tr_b16 a[152:153], v39 offset:16384
    ds_read_b64_tr_b16 a[154:155], v39 offset:20480
    v_mfma_f32_16x16x32_bf16 v[228:231], v[60:63], a[200:203], v[228:231]
    v_exp_f32 v101, v101
    v_mfma_f32_16x16x32_bf16 v[228:231], v[64:67], a[204:207], v[228:231]
    ds_read_b64_tr_b16 a[156:157], v39 offset:24576
    v_cvt_pk_bf16_f32 v54, v100, v101
    v_mfma_f32_16x16x32_bf16 v[232:235], v[60:63], a[208:211], v[232:235]
    v_exp_f32 v102, v102
    v_mfma_f32_16x16x32_bf16 v[232:235], v[64:67], a[212:215], v[232:235]
    ds_read_b64_tr_b16 a[158:159], v39 offset:28672
    ds_read_b64_tr_b16 a[160:161], v40 offset:16384
    v_mfma_f32_16x16x32_bf16 v[236:239], v[60:63], a[216:219], v[236:239]
    v_exp_f32 v103, v103
    v_mfma_f32_16x16x32_bf16 v[236:239], v[64:67], a[220:223], v[236:239]
    ds_read_b64_tr_b16 a[162:163], v40 offset:20480
    v_cvt_pk_bf16_f32 v55, v102, v103
    v_mfma_f32_16x16x32_bf16 v[240:243], v[60:63], a[224:227], v[240:243]
    v_exp_f32 v104, v104
    v_mfma_f32_16x16x32_bf16 v[240:243], v[64:67], a[228:231], v[240:243]
    ds_read_b64_tr_b16 a[164:165], v40 offset:24576
    ds_read_b64_tr_b16 a[166:167], v40 offset:28672
    v_mfma_f32_16x16x32_bf16 v[244:247], v[60:63], a[232:235], v[244:247]
    v_exp_f32 v105, v105
    v_mfma_f32_16x16x32_bf16 v[244:247], v[64:67], a[236:239], v[244:247]
    ds_read_b64_tr_b16 a[168:169], v41 offset:16384
    v_cvt_pk_bf16_f32 v56, v104, v105
    v_mfma_f32_16x16x32_bf16 v[248:251], v[60:63], a[240:243], v[248:251]
    v_exp_f32 v106, v106
    v_mfma_f32_16x16x32_bf16 v[248:251], v[64:67], a[244:247], v[248:251]
    ds_read_b64_tr_b16 a[170:171], v41 offset:20480
    ds_read_b64_tr_b16 a[172:173], v41 offset:24576
    v_mfma_f32_16x16x32_bf16 v[252:255], v[60:63], a[248:251], v[252:255]
    v_exp_f32 v107, v107
    v_mfma_f32_16x16x32_bf16 v[252:255], v[64:67], a[252:255], v[252:255]
    ds_read_b64_tr_b16 a[174:175], v41 offset:28672
    v_cvt_pk_bf16_f32 v57, v106, v107
    v_mfma_f32_16x16x32_bf16 v[112:115], a[64:67], a[16:19], v[72:75]
    v_exp_f32 v108, v108
    v_mfma_f32_16x16x32_bf16 v[112:115], a[68:71], a[20:23], v[112:115]
    ds_read_b64_tr_b16 a[176:177], v42 offset:16384
    ds_read_b64_tr_b16 a[178:179], v42 offset:20480
    v_mfma_f32_16x16x32_bf16 v[112:115], a[72:75], a[24:27], v[112:115]
    v_exp_f32 v109, v109
    v_mfma_f32_16x16x32_bf16 v[112:115], a[76:79], a[28:31], v[112:115]
    s_waitcnt vmcnt(4)
    ds_read_b64_tr_b16 a[180:181], v42 offset:24576
    v_cvt_pk_bf16_f32 v58, v108, v109
    s_barrier
    v_mfma_f32_16x16x32_bf16 v[116:119], a[92:95], a[28:31], v[72:75]
    v_exp_f32 v110, v110
    v_mfma_f32_16x16x32_bf16 v[116:119], a[88:91], a[24:27], v[116:119]
    ds_read_b64_tr_b16 a[182:183], v42 offset:28672
    ds_read_b64_tr_b16 a[184:185], v43 offset:16384
    v_mfma_f32_16x16x32_bf16 v[116:119], a[84:87], a[20:23], v[116:119]
    v_exp_f32 v111, v111
    v_mfma_f32_16x16x32_bf16 v[116:119], a[80:83], a[16:19], v[116:119]
    ds_read_b64_tr_b16 a[186:187], v43 offset:20480
    v_cvt_pk_bf16_f32 v59, v110, v111
    v_mfma_f32_16x16x32_bf16 v[120:123], a[96:99], a[16:19], v[72:75]
    v_exp_f32 v112, v112
    v_mfma_f32_16x16x32_bf16 v[120:123], a[100:103], a[20:23], v[120:123]
    ds_read_b64_tr_b16 a[188:189], v43 offset:24576
    ds_read_b64_tr_b16 a[190:191], v43 offset:28672
    v_mfma_f32_16x16x32_bf16 v[120:123], a[104:107], a[24:27], v[120:123]
    v_exp_f32 v113, v113
    v_mfma_f32_16x16x32_bf16 v[120:123], a[108:111], a[28:31], v[120:123]
    ds_read_b128 a[64:67], v32 offset:32768
    v_cvt_pk_bf16_f32 v60, v112, v113
    v_mfma_f32_16x16x32_bf16 v[124:127], a[124:127], a[28:31], v[72:75]
    v_exp_f32 v114, v114
    v_mfma_f32_16x16x32_bf16 v[124:127], a[120:123], a[24:27], v[124:127]
    ds_read_b128 a[68:71], v33 offset:32768
    ds_read_b128 a[72:75], v34 offset:32768
    v_mfma_f32_16x16x32_bf16 v[124:127], a[116:119], a[20:23], v[124:127]
    v_exp_f32 v115, v115
    v_mfma_f32_16x16x32_bf16 v[124:127], a[112:115], a[16:19], v[124:127]
    s_waitcnt lgkmcnt(14)
    ds_read_b128 a[76:79], v35 offset:32768
    v_cvt_pk_bf16_f32 v61, v114, v115
    v_smfmac_f32_16x16x64_bf16 v[44:47], v[20:23], v[52:59], v24
    v_mfma_f32_16x16x32_bf16 v[128:131], v[52:55], a[128:131], v[128:131]
    v_exp_f32 v116, v116
    v_mfma_f32_16x16x32_bf16 v[128:131], v[56:59], a[132:135], v[128:131]
    ds_read_b128 a[92:95], v35 offset:36864
    ds_read_b128 a[88:91], v34 offset:36864
    v_mfma_f32_16x16x32_bf16 v[132:135], v[52:55], a[136:139], v[132:135]
    v_exp_f32 v117, v117
    v_mfma_f32_16x16x32_bf16 v[132:135], v[56:59], a[140:143], v[132:135]
    ds_read_b128 a[84:87], v33 offset:36864
    v_cvt_pk_bf16_f32 v62, v116, v117
    v_mfma_f32_16x16x32_bf16 v[136:139], v[52:55], a[144:147], v[136:139]
    v_exp_f32 v118, v118
    v_mfma_f32_16x16x32_bf16 v[136:139], v[56:59], a[148:151], v[136:139]
    ds_read_b128 a[80:83], v32 offset:36864
    ds_read_b128 a[96:99], v32 offset:40960
    v_mfma_f32_16x16x32_bf16 v[140:143], v[52:55], a[152:155], v[140:143]
    v_exp_f32 v119, v119
    v_mfma_f32_16x16x32_bf16 v[140:143], v[56:59], a[156:159], v[140:143]
    ds_read_b128 a[100:103], v33 offset:40960
    v_cvt_pk_bf16_f32 v63, v118, v119
    v_mfma_f32_16x16x32_bf16 v[144:147], v[52:55], a[160:163], v[144:147]
    v_exp_f32 v120, v120
    v_mfma_f32_16x16x32_bf16 v[144:147], v[56:59], a[164:167], v[144:147]
    s_waitcnt lgkmcnt(14)
    ds_read_b128 a[104:107], v34 offset:40960
    ds_read_b128 a[108:111], v35 offset:40960
    v_mfma_f32_16x16x32_bf16 v[148:151], v[52:55], a[168:171], v[148:151]
    v_exp_f32 v121, v121
    v_mfma_f32_16x16x32_bf16 v[148:151], v[56:59], a[172:175], v[148:151]
    ds_read_b128 a[124:127], v35 offset:45056
    v_cvt_pk_bf16_f32 v64, v120, v121
    v_mfma_f32_16x16x32_bf16 v[152:155], v[52:55], a[176:179], v[152:155]
    v_exp_f32 v122, v122
    v_mfma_f32_16x16x32_bf16 v[152:155], v[56:59], a[180:183], v[152:155]
    s_waitcnt lgkmcnt(13)
    ds_read_b128 a[120:123], v34 offset:45056
    ds_read_b128 a[116:119], v33 offset:45056
    v_mfma_f32_16x16x32_bf16 v[156:159], v[52:55], a[184:187], v[156:159]
    v_exp_f32 v123, v123
    v_mfma_f32_16x16x32_bf16 v[156:159], v[56:59], a[188:191], v[156:159]
    s_waitcnt vmcnt(0)
    s_waitcnt lgkmcnt(11)
    ds_read_b128 a[112:115], v32 offset:45056
    v_cvt_pk_bf16_f32 v65, v122, v123
    s_barrier
    v_mfma_f32_16x16x32_bf16 v[96:99], a[64:67], a[0:3], v[68:71]
    v_exp_f32 v124, v124
    v_mfma_f32_16x16x32_bf16 v[96:99], a[68:71], a[4:7], v[96:99]
    ds_read_b64_tr_b16 a[192:193], v36 offset:32768
    ds_read_b64_tr_b16 a[194:195], v36 offset:36864
    v_mfma_f32_16x16x32_bf16 v[96:99], a[72:75], a[8:11], v[96:99]
    v_exp_f32 v125, v125
    v_mfma_f32_16x16x32_bf16 v[96:99], a[76:79], a[12:15], v[96:99]
    s_waitcnt lgkmcnt(10)
    ds_read_b64_tr_b16 a[196:197], v36 offset:40960
    v_cvt_pk_bf16_f32 v66, v124, v125
    v_mfma_f32_16x16x32_bf16 v[100:103], a[92:95], a[12:15], v[68:71]
    v_exp_f32 v126, v126
    v_mfma_f32_16x16x32_bf16 v[100:103], a[88:91], a[8:11], v[100:103]
    ds_read_b64_tr_b16 a[198:199], v36 offset:45056
    ds_read_b64_tr_b16 a[200:201], v37 offset:32768
    v_mfma_f32_16x16x32_bf16 v[100:103], a[84:87], a[4:7], v[100:103]
    v_exp_f32 v127, v127
    v_mfma_f32_16x16x32_bf16 v[100:103], a[80:83], a[0:3], v[100:103]
    s_waitcnt lgkmcnt(9)
    ds_read_b64_tr_b16 a[202:203], v37 offset:36864
    v_cvt_pk_bf16_f32 v67, v126, v127
    v_mfma_f32_16x16x32_bf16 v[104:107], a[96:99], a[0:3], v[68:71]
    v_exp_f32 v96, v96
    v_mfma_f32_16x16x32_bf16 v[104:107], a[100:103], a[4:7], v[104:107]
    ds_read_b64_tr_b16 a[204:205], v37 offset:40960
    ds_read_b64_tr_b16 a[206:207], v37 offset:45056
    v_mfma_f32_16x16x32_bf16 v[104:107], a[104:107], a[8:11], v[104:107]
    v_exp_f32 v97, v97
    v_mfma_f32_16x16x32_bf16 v[104:107], a[108:111], a[12:15], v[104:107]
    s_waitcnt lgkmcnt(8)
    ds_read_b64_tr_b16 a[208:209], v38 offset:32768
    v_cvt_pk_bf16_f32 v52, v96, v97
    v_mfma_f32_16x16x32_bf16 v[108:111], a[124:127], a[12:15], v[68:71]
    v_exp_f32 v98, v98
    v_mfma_f32_16x16x32_bf16 v[108:111], a[120:123], a[8:11], v[108:111]
    ds_read_b64_tr_b16 a[210:211], v38 offset:36864
    ds_read_b64_tr_b16 a[212:213], v38 offset:40960
    v_mfma_f32_16x16x32_bf16 v[108:111], a[116:119], a[4:7], v[108:111]
    v_exp_f32 v99, v99
    v_mfma_f32_16x16x32_bf16 v[108:111], a[112:115], a[0:3], v[108:111]
    ds_read_b64_tr_b16 a[214:215], v38 offset:45056
    v_cvt_pk_bf16_f32 v53, v98, v99
    v_smfmac_f32_16x16x64_bf16 v[48:51], v[20:23], v[60:67], v24
    v_mfma_f32_16x16x32_bf16 v[160:163], v[60:63], a[128:131], v[160:163]
    v_exp_f32 v100, v100
    v_mfma_f32_16x16x32_bf16 v[160:163], v[64:67], a[132:135], v[160:163]
    ds_read_b64_tr_b16 a[216:217], v39 offset:32768
    ds_read_b64_tr_b16 a[218:219], v39 offset:36864
    v_mfma_f32_16x16x32_bf16 v[164:167], v[60:63], a[136:139], v[164:167]
    v_exp_f32 v101, v101
    v_mfma_f32_16x16x32_bf16 v[164:167], v[64:67], a[140:143], v[164:167]
    ds_read_b64_tr_b16 a[220:221], v39 offset:40960
    v_cvt_pk_bf16_f32 v54, v100, v101
    v_mfma_f32_16x16x32_bf16 v[168:171], v[60:63], a[144:147], v[168:171]
    v_exp_f32 v102, v102
    v_mfma_f32_16x16x32_bf16 v[168:171], v[64:67], a[148:151], v[168:171]
    ds_read_b64_tr_b16 a[222:223], v39 offset:45056
    ds_read_b64_tr_b16 a[224:225], v40 offset:32768
    v_mfma_f32_16x16x32_bf16 v[172:175], v[60:63], a[152:155], v[172:175]
    v_exp_f32 v103, v103
    v_mfma_f32_16x16x32_bf16 v[172:175], v[64:67], a[156:159], v[172:175]
    ds_read_b64_tr_b16 a[226:227], v40 offset:36864
    v_cvt_pk_bf16_f32 v55, v102, v103
    v_mfma_f32_16x16x32_bf16 v[176:179], v[60:63], a[160:163], v[176:179]
    v_exp_f32 v104, v104
    v_mfma_f32_16x16x32_bf16 v[176:179], v[64:67], a[164:167], v[176:179]
    ds_read_b64_tr_b16 a[228:229], v40 offset:40960
    ds_read_b64_tr_b16 a[230:231], v40 offset:45056
    v_mfma_f32_16x16x32_bf16 v[180:183], v[60:63], a[168:171], v[180:183]
    v_exp_f32 v105, v105
    v_mfma_f32_16x16x32_bf16 v[180:183], v[64:67], a[172:175], v[180:183]
    ds_read_b64_tr_b16 a[232:233], v41 offset:32768
    v_cvt_pk_bf16_f32 v56, v104, v105
    v_mfma_f32_16x16x32_bf16 v[184:187], v[60:63], a[176:179], v[184:187]
    v_exp_f32 v106, v106
    v_mfma_f32_16x16x32_bf16 v[184:187], v[64:67], a[180:183], v[184:187]
    ds_read_b64_tr_b16 a[234:235], v41 offset:36864
    ds_read_b64_tr_b16 a[236:237], v41 offset:40960
    v_mfma_f32_16x16x32_bf16 v[188:191], v[60:63], a[184:187], v[188:191]
    v_exp_f32 v107, v107
    v_mfma_f32_16x16x32_bf16 v[188:191], v[64:67], a[188:191], v[188:191]
    ds_read_b64_tr_b16 a[238:239], v41 offset:45056
    v_cvt_pk_bf16_f32 v57, v106, v107
    v_mfma_f32_16x16x32_bf16 v[112:115], a[64:67], a[16:19], v[72:75]
    v_exp_f32 v108, v108
    v_mfma_f32_16x16x32_bf16 v[112:115], a[68:71], a[20:23], v[112:115]
    ds_read_b64_tr_b16 a[240:241], v42 offset:32768
    ds_read_b64_tr_b16 a[242:243], v42 offset:36864
    v_mfma_f32_16x16x32_bf16 v[112:115], a[72:75], a[24:27], v[112:115]
    v_exp_f32 v109, v109
    v_mfma_f32_16x16x32_bf16 v[112:115], a[76:79], a[28:31], v[112:115]
    ds_read_b64_tr_b16 a[244:245], v42 offset:40960
    v_cvt_pk_bf16_f32 v58, v108, v109
    v_mfma_f32_16x16x32_bf16 v[116:119], a[92:95], a[28:31], v[72:75]
    v_exp_f32 v110, v110
    v_mfma_f32_16x16x32_bf16 v[116:119], a[88:91], a[24:27], v[116:119]
    ds_read_b64_tr_b16 a[246:247], v42 offset:45056
    ds_read_b64_tr_b16 a[248:249], v43 offset:32768
    v_mfma_f32_16x16x32_bf16 v[116:119], a[84:87], a[20:23], v[116:119]
    v_exp_f32 v111, v111
    v_mfma_f32_16x16x32_bf16 v[116:119], a[80:83], a[16:19], v[116:119]
    ds_read_b64_tr_b16 a[250:251], v43 offset:36864
    v_cvt_pk_bf16_f32 v59, v110, v111
    v_mfma_f32_16x16x32_bf16 v[120:123], a[96:99], a[16:19], v[72:75]
    v_exp_f32 v112, v112
    v_mfma_f32_16x16x32_bf16 v[120:123], a[100:103], a[20:23], v[120:123]
    ds_read_b64_tr_b16 a[252:253], v43 offset:40960
    ds_read_b64_tr_b16 a[254:255], v43 offset:45056
    v_mfma_f32_16x16x32_bf16 v[120:123], a[104:107], a[24:27], v[120:123]
    v_exp_f32 v113, v113
    v_mfma_f32_16x16x32_bf16 v[120:123], a[108:111], a[28:31], v[120:123]
    ds_read_b128 a[64:67], v32 offset:16384
    v_cvt_pk_bf16_f32 v60, v112, v113
    v_mfma_f32_16x16x32_bf16 v[124:127], a[124:127], a[28:31], v[72:75]
    v_exp_f32 v114, v114
    v_mfma_f32_16x16x32_bf16 v[124:127], a[120:123], a[24:27], v[124:127]
    ds_read_b128 a[68:71], v33 offset:16384
    ds_read_b128 a[72:75], v34 offset:16384
    v_mfma_f32_16x16x32_bf16 v[124:127], a[116:119], a[20:23], v[124:127]
    v_exp_f32 v115, v115
    v_mfma_f32_16x16x32_bf16 v[124:127], a[112:115], a[16:19], v[124:127]
    s_waitcnt lgkmcnt(14)
    ds_read_b128 a[76:79], v35 offset:16384
    v_cvt_pk_bf16_f32 v61, v114, v115
    v_smfmac_f32_16x16x64_bf16 v[44:47], v[20:23], v[52:59], v24
    v_mfma_f32_16x16x32_bf16 v[128:131], v[52:55], a[192:195], v[128:131]
    v_exp_f32 v116, v116
    v_mfma_f32_16x16x32_bf16 v[128:131], v[56:59], a[196:199], v[128:131]
    ds_read_b128 a[92:95], v35 offset:20480
    ds_read_b128 a[88:91], v34 offset:20480
    v_mfma_f32_16x16x32_bf16 v[132:135], v[52:55], a[200:203], v[132:135]
    v_exp_f32 v117, v117
    v_mfma_f32_16x16x32_bf16 v[132:135], v[56:59], a[204:207], v[132:135]
    ds_read_b128 a[84:87], v33 offset:20480
    v_cvt_pk_bf16_f32 v62, v116, v117
    v_mfma_f32_16x16x32_bf16 v[136:139], v[52:55], a[208:211], v[136:139]
    v_exp_f32 v118, v118
    v_mfma_f32_16x16x32_bf16 v[136:139], v[56:59], a[212:215], v[136:139]
    ds_read_b128 a[80:83], v32 offset:20480
    ds_read_b128 a[96:99], v32 offset:24576
    v_mfma_f32_16x16x32_bf16 v[140:143], v[52:55], a[216:219], v[140:143]
    v_exp_f32 v119, v119
    v_mfma_f32_16x16x32_bf16 v[140:143], v[56:59], a[220:223], v[140:143]
    ds_read_b128 a[100:103], v33 offset:24576
    v_cvt_pk_bf16_f32 v63, v118, v119
    v_mfma_f32_16x16x32_bf16 v[144:147], v[52:55], a[224:227], v[144:147]
    v_exp_f32 v120, v120
    v_mfma_f32_16x16x32_bf16 v[144:147], v[56:59], a[228:231], v[144:147]
    s_waitcnt lgkmcnt(14)
    ds_read_b128 a[104:107], v34 offset:24576
    ds_read_b128 a[108:111], v35 offset:24576
    v_add_f32 v92, v44, v45
    v_cmp_ngt_f32_e64 s[66:67], s59, v92
    v_mfma_f32_16x16x32_bf16 v[148:151], v[52:55], a[232:235], v[148:151]
    v_exp_f32 v121, v121
    v_mfma_f32_16x16x32_bf16 v[148:151], v[56:59], a[236:239], v[148:151]
    ds_read_b128 a[124:127], v35 offset:28672
    v_cvt_pk_bf16_f32 v64, v120, v121
    v_rcp_f32 v92, v92
    v_mfma_f32_16x16x32_bf16 v[152:155], v[52:55], a[240:243], v[152:155]
    v_exp_f32 v122, v122
    v_mfma_f32_16x16x32_bf16 v[152:155], v[56:59], a[244:247], v[152:155]
    s_waitcnt lgkmcnt(13)
    ds_read_b128 a[120:123], v34 offset:28672
    ds_read_b128 a[116:119], v33 offset:28672
    v_mfma_f32_16x16x32_bf16 v[156:159], v[52:55], a[248:251], v[156:159]
    v_exp_f32 v123, v123
    v_mfma_f32_16x16x32_bf16 v[156:159], v[56:59], a[252:255], v[156:159]
    s_waitcnt lgkmcnt(11)
    ds_read_b128 a[112:115], v32 offset:28672
    v_cvt_pk_bf16_f32 v65, v122, v123
    ds_bpermute_b32 v44, v31, v92 offset:0
    v_mfma_f32_16x16x32_bf16 v[96:99], a[64:67], a[32:35], v[76:79]
    v_exp_f32 v124, v124
    v_mfma_f32_16x16x32_bf16 v[96:99], a[68:71], a[36:39], v[96:99]
    ds_bpermute_b32 v45, v31, v92 offset:4
    ds_bpermute_b32 v46, v31, v92 offset:8
    v_mfma_f32_16x16x32_bf16 v[96:99], a[72:75], a[40:43], v[96:99]
    v_exp_f32 v125, v125
    v_mfma_f32_16x16x32_bf16 v[96:99], a[76:79], a[44:47], v[96:99]
    s_waitcnt lgkmcnt(11)
    v_cvt_pk_bf16_f32 v66, v124, v125
    ds_bpermute_b32 v47, v31, v92 offset:12
    v_mfma_f32_16x16x32_bf16 v[100:103], a[92:95], a[44:47], v[76:79]
    v_exp_f32 v126, v126
    v_mfma_f32_16x16x32_bf16 v[100:103], a[88:91], a[40:43], v[100:103]
    v_mfma_f32_16x16x32_bf16 v[100:103], a[84:87], a[36:39], v[100:103]
    v_exp_f32 v127, v127
    v_mfma_f32_16x16x32_bf16 v[100:103], a[80:83], a[32:35], v[100:103]
    v_cvt_pk_bf16_f32 v67, v126, v127
    s_waitcnt lgkmcnt(0)
    v_pk_mul_f32 v[128:129], v[128:129], v[44:45]
    v_pk_mul_f32 v[132:133], v[132:133], v[44:45]
    v_pk_mul_f32 v[136:137], v[136:137], v[44:45]
    v_pk_mul_f32 v[140:141], v[140:141], v[44:45]
    v_pk_mul_f32 v[144:145], v[144:145], v[44:45]
    v_pk_mul_f32 v[148:149], v[148:149], v[44:45]
    v_pk_mul_f32 v[152:153], v[152:153], v[44:45]
    v_pk_mul_f32 v[156:157], v[156:157], v[44:45]
    v_pk_mul_f32 v[130:131], v[130:131], v[46:47]
    v_pk_mul_f32 v[134:135], v[134:135], v[46:47]
    v_pk_mul_f32 v[138:139], v[138:139], v[46:47]
    v_pk_mul_f32 v[142:143], v[142:143], v[46:47]
    v_pk_mul_f32 v[146:147], v[146:147], v[46:47]
    v_pk_mul_f32 v[150:151], v[150:151], v[46:47]
    v_pk_mul_f32 v[154:155], v[154:155], v[46:47]
    v_pk_mul_f32 v[158:159], v[158:159], v[46:47]
    v_mfma_f32_16x16x32_bf16 v[104:107], a[96:99], a[32:35], v[76:79]
    v_exp_f32 v96, v96
    v_mfma_f32_16x16x32_bf16 v[104:107], a[100:103], a[36:39], v[104:107]
    v_cvt_pk_bf16_f32 v0, v128, v132
    v_cvt_pk_bf16_f32 v1, v136, v140
    v_mfma_f32_16x16x32_bf16 v[104:107], a[104:107], a[40:43], v[104:107]
    v_exp_f32 v97, v97
    v_mfma_f32_16x16x32_bf16 v[104:107], a[108:111], a[44:47], v[104:107]
    v_cvt_pk_bf16_f32 v52, v96, v97
    v_cvt_pk_bf16_f32 v2, v144, v148
    v_cvt_pk_bf16_f32 v3, v152, v156
    v_smfmac_f32_16x16x64_bf16 v[48:51], v[20:23], v[60:67], v24
    v_mfma_f32_16x16x32_bf16 v[108:111], a[124:127], a[44:47], v[76:79]
    s_cmp_lg_u32 s2, s2
    v_exp_f32 v98, v98
    v_mfma_f32_16x16x32_bf16 v[108:111], a[120:123], a[40:43], v[108:111]
L_pg:
    s_cbranch_scc1 L_pgback
    ds_write_b128 v16, v[0:3] offset:0
    v_mfma_f32_16x16x32_bf16 v[108:111], a[116:119], a[36:39], v[108:111]
    v_exp_f32 v99, v99
    v_mfma_f32_16x16x32_bf16 v[108:111], a[112:115], a[32:35], v[108:111]
    v_cvt_pk_bf16_f32 v53, v98, v99
    v_cvt_pk_bf16_f32 v4, v129, v133
    v_cvt_pk_bf16_f32 v5, v137, v141
    v_cvt_pk_bf16_f32 v6, v145, v149
    v_cvt_pk_bf16_f32 v7, v153, v157
    v_mfma_f32_16x16x32_bf16 v[160:163], v[60:63], a[192:195], v[160:163]
    v_exp_f32 v100, v100
    v_mfma_f32_16x16x32_bf16 v[160:163], v[64:67], a[196:199], v[160:163]
    ds_write_b128 v17, v[4:7] offset:1024
    v_mfma_f32_16x16x32_bf16 v[164:167], v[60:63], a[200:203], v[164:167]
    v_exp_f32 v101, v101
    v_mfma_f32_16x16x32_bf16 v[164:167], v[64:67], a[204:207], v[164:167]
    v_cvt_pk_bf16_f32 v54, v100, v101
    v_cvt_pk_bf16_f32 v8, v130, v134
    v_cvt_pk_bf16_f32 v9, v138, v142
    v_cvt_pk_bf16_f32 v10, v146, v150
    v_cvt_pk_bf16_f32 v11, v154, v158
    v_mfma_f32_16x16x32_bf16 v[168:171], v[60:63], a[208:211], v[168:171]
    v_exp_f32 v102, v102
    v_mfma_f32_16x16x32_bf16 v[168:171], v[64:67], a[212:215], v[168:171]
    ds_write_b128 v16, v[8:11] offset:8192
    v_mfma_f32_16x16x32_bf16 v[172:175], v[60:63], a[216:219], v[172:175]
    v_exp_f32 v103, v103
    v_mfma_f32_16x16x32_bf16 v[172:175], v[64:67], a[220:223], v[172:175]
    v_cvt_pk_bf16_f32 v55, v102, v103
    v_cvt_pk_bf16_f32 v12, v131, v135
    v_cvt_pk_bf16_f32 v13, v139, v143
    v_cvt_pk_bf16_f32 v14, v147, v151
    v_cvt_pk_bf16_f32 v15, v155, v159
    v_mfma_f32_16x16x32_bf16 v[176:179], v[60:63], a[224:227], v[176:179]
    v_exp_f32 v104, v104
    v_mfma_f32_16x16x32_bf16 v[176:179], v[64:67], a[228:231], v[176:179]
    ds_write_b128 v17, v[12:15] offset:9216
    v_mfma_f32_16x16x32_bf16 v[180:183], v[60:63], a[232:235], v[180:183]
    v_exp_f32 v105, v105
    v_mfma_f32_16x16x32_bf16 v[180:183], v[64:67], a[236:239], v[180:183]
    v_cvt_pk_bf16_f32 v56, v104, v105
    ds_read_b64_tr_b16 v[128:129], v18 offset:0
    ds_read_b64_tr_b16 v[130:131], v19 offset:0
    v_mfma_f32_16x16x32_bf16 v[184:187], v[60:63], a[240:243], v[184:187]
    v_exp_f32 v106, v106
    v_mfma_f32_16x16x32_bf16 v[184:187], v[64:67], a[244:247], v[184:187]
    v_add_f32 v92, v48, v49
    v_cmp_ngt_f32_e64 s[68:69], s59, v92
    ds_read_b64_tr_b16 v[132:133], v18 offset:256
    v_mfma_f32_16x16x32_bf16 v[188:191], v[60:63], a[248:251], v[188:191]
    v_exp_f32 v107, v107
    v_mfma_f32_16x16x32_bf16 v[188:191], v[64:67], a[252:255], v[188:191]
    v_cvt_pk_bf16_f32 v57, v106, v107
    v_rcp_f32 v92, v92
    v_mfma_f32_16x16x32_bf16 v[112:115], a[64:67], a[48:51], v[80:83]
    v_exp_f32 v108, v108
    v_mfma_f32_16x16x32_bf16 v[112:115], a[68:71], a[52:55], v[112:115]
    ds_bpermute_b32 v48, v31, v92 offset:0
    ds_read_b64_tr_b16 v[134:135], v19 offset:256
    v_mfma_f32_16x16x32_bf16 v[112:115], a[72:75], a[56:59], v[112:115]
    v_exp_f32 v109, v109
    v_mfma_f32_16x16x32_bf16 v[112:115], a[76:79], a[60:63], v[112:115]
    ds_read_b128 a[64:67], v32 offset:32768
    v_cvt_pk_bf16_f32 v58, v108, v109
    ds_read_b64_tr_b16 v[136:137], v18 offset:512
    ds_read_b64_tr_b16 v[138:139], v19 offset:512
    v_mfma_f32_16x16x32_bf16 v[116:119], a[92:95], a[60:63], v[80:83]
    v_exp_f32 v110, v110
    v_mfma_f32_16x16x32_bf16 v[116:119], a[88:91], a[56:59], v[116:119]
    ds_read_b128 a[68:71], v33 offset:32768
    ds_read_b128 a[72:75], v34 offset:32768
    ds_read_b64_tr_b16 v[140:141], v18 offset:768
    ds_read_b64_tr_b16 v[142:143], v19 offset:768
    v_mfma_f32_16x16x32_bf16 v[116:119], a[84:87], a[52:55], v[116:119]
    v_exp_f32 v111, v111
    v_mfma_f32_16x16x32_bf16 v[116:119], a[80:83], a[48:51], v[116:119]
    ds_read_b128 a[76:79], v35 offset:32768
    v_cvt_pk_bf16_f32 v59, v110, v111
    ds_bpermute_b32 v49, v31, v92 offset:4
    v_mfma_f32_16x16x32_bf16 v[120:123], a[96:99], a[48:51], v[80:83]
    v_exp_f32 v112, v112
    v_mfma_f32_16x16x32_bf16 v[120:123], a[100:103], a[52:55], v[120:123]
    s_waitcnt lgkmcnt(12)
    buffer_store_dwordx4 v[128:131], v30, s[28:31], 0 offen sc1
    ds_bpermute_b32 v50, v31, v92 offset:8
    v_mfma_f32_16x16x32_bf16 v[120:123], a[104:107], a[56:59], v[120:123]
    v_exp_f32 v113, v113
    v_mfma_f32_16x16x32_bf16 v[120:123], a[108:111], a[60:63], v[120:123]
    ds_read_b128 a[92:95], v35 offset:36864
    v_cvt_pk_bf16_f32 v60, v112, v113
    ds_bpermute_b32 v51, v31, v92 offset:12
    v_mfma_f32_16x16x32_bf16 v[124:127], a[124:127], a[60:63], v[80:83]
    v_exp_f32 v114, v114
    v_mfma_f32_16x16x32_bf16 v[124:127], a[120:123], a[56:59], v[124:127]
    s_waitcnt lgkmcnt(12)
    buffer_store_dwordx4 v[132:135], v30, s[28:31], 0 offen offset:1024 sc1
    v_mfma_f32_16x16x32_bf16 v[124:127], a[116:119], a[52:55], v[124:127]
    v_exp_f32 v115, v115
    v_mfma_f32_16x16x32_bf16 v[124:127], a[112:115], a[48:51], v[124:127]
    ds_read_b128 a[88:91], v34 offset:36864
    v_cvt_pk_bf16_f32 v61, v114, v115
    v_smfmac_f32_16x16x64_bf16 v[84:87], v[20:23], v[52:59], v24
    v_mfma_f32_16x16x32_bf16 v[192:195], v[52:55], a[128:131], v[192:195]
    v_exp_f32 v116, v116
    v_mfma_f32_16x16x32_bf16 v[192:195], v[56:59], a[132:135], v[192:195]
    s_waitcnt lgkmcnt(10)
    ds_read_b128 a[84:87], v33 offset:36864
    ds_read_b128 a[80:83], v32 offset:36864
    buffer_store_dwordx4 v[136:139], v30, s[28:31], 0 offen offset:2048 sc1
    s_waitcnt lgkmcnt(3)
    v_pk_mul_f32 v[160:161], v[160:161], v[48:49]
    v_pk_mul_f32 v[164:165], v[164:165], v[48:49]
    v_pk_mul_f32 v[168:169], v[168:169], v[48:49]
    v_pk_mul_f32 v[172:173], v[172:173], v[48:49]
    v_pk_mul_f32 v[176:177], v[176:177], v[48:49]
    v_pk_mul_f32 v[180:181], v[180:181], v[48:49]
    v_pk_mul_f32 v[184:185], v[184:185], v[48:49]
    v_pk_mul_f32 v[188:189], v[188:189], v[48:49]
    v_pk_mul_f32 v[162:163], v[162:163], v[50:51]
    v_pk_mul_f32 v[166:167], v[166:167], v[50:51]
    v_pk_mul_f32 v[170:171], v[170:171], v[50:51]
    v_pk_mul_f32 v[174:175], v[174:175], v[50:51]
    v_pk_mul_f32 v[178:179], v[178:179], v[50:51]
    v_pk_mul_f32 v[182:183], v[182:183], v[50:51]
    v_pk_mul_f32 v[186:187], v[186:187], v[50:51]
    v_pk_mul_f32 v[190:191], v[190:191], v[50:51]
    v_mfma_f32_16x16x32_bf16 v[196:199], v[52:55], a[136:139], v[196:199]
    v_exp_f32 v117, v117
    v_mfma_f32_16x16x32_bf16 v[196:199], v[56:59], a[140:143], v[196:199]
    ds_read_b128 a[96:99], v32 offset:40960
    v_cvt_pk_bf16_f32 v62, v116, v117
    v_cvt_pk_bf16_f32 v0, v160, v164
    v_mfma_f32_16x16x32_bf16 v[200:203], v[52:55], a[144:147], v[200:203]
    v_exp_f32 v118, v118
    v_mfma_f32_16x16x32_bf16 v[200:203], v[56:59], a[148:151], v[200:203]
    buffer_store_dwordx4 v[140:143], v30, s[28:31], 0 offen offset:3072 sc1
    v_cvt_pk_bf16_f32 v1, v168, v172
    v_mfma_f32_16x16x32_bf16 v[204:207], v[52:55], a[152:155], v[204:207]
    v_exp_f32 v119, v119
    v_mfma_f32_16x16x32_bf16 v[204:207], v[56:59], a[156:159], v[204:207]
    ds_read_b128 a[100:103], v33 offset:40960
    v_cvt_pk_bf16_f32 v63, v118, v119
    v_cvt_pk_bf16_f32 v2, v176, v180
    v_cvt_pk_bf16_f32 v3, v184, v188
    v_mfma_f32_16x16x32_bf16 v[208:211], v[52:55], a[160:163], v[208:211]
    v_exp_f32 v120, v120
    v_mfma_f32_16x16x32_bf16 v[208:211], v[56:59], a[164:167], v[208:211]
    ds_write_b128 v16, v[0:3] offset:49152
    v_mfma_f32_16x16x32_bf16 v[212:215], v[52:55], a[168:171], v[212:215]
    v_exp_f32 v121, v121
    v_mfma_f32_16x16x32_bf16 v[212:215], v[56:59], a[172:175], v[212:215]
    ds_read_b128 a[104:107], v34 offset:40960
    v_cvt_pk_bf16_f32 v64, v120, v121
    v_cvt_pk_bf16_f32 v4, v161, v165
    v_mfma_f32_16x16x32_bf16 v[216:219], v[52:55], a[176:179], v[216:219]
    v_exp_f32 v122, v122
    v_mfma_f32_16x16x32_bf16 v[216:219], v[56:59], a[180:183], v[216:219]
    ds_read_b128 a[108:111], v35 offset:40960
    ds_read_b128 a[124:127], v35 offset:45056
    v_cvt_pk_bf16_f32 v5, v169, v173
    v_mfma_f32_16x16x32_bf16 v[220:223], v[52:55], a[184:187], v[220:223]
    v_exp_f32 v123, v123
    v_mfma_f32_16x16x32_bf16 v[220:223], v[56:59], a[188:191], v[220:223]
    ds_read_b128 a[120:123], v34 offset:45056
    v_cvt_pk_bf16_f32 v65, v122, v123
    v_cvt_pk_bf16_f32 v6, v177, v181
    v_cvt_pk_bf16_f32 v7, v185, v189
    v_mfma_f32_16x16x32_bf16 v[96:99], a[64:67], a[32:35], v[76:79]
    v_exp_f32 v124, v124
    v_mfma_f32_16x16x32_bf16 v[96:99], a[68:71], a[36:39], v[96:99]
    ds_write_b128 v17, v[4:7] offset:50176
    v_mfma_f32_16x16x32_bf16 v[96:99], a[72:75], a[40:43], v[96:99]
    v_exp_f32 v125, v125
    v_mfma_f32_16x16x32_bf16 v[96:99], a[76:79], a[44:47], v[96:99]
    s_waitcnt lgkmcnt(8)
    ds_read_b128 a[116:119], v33 offset:45056
    v_cvt_pk_bf16_f32 v66, v124, v125
    v_mfma_f32_16x16x32_bf16 v[100:103], a[92:95], a[44:47], v[76:79]
    v_exp_f32 v126, v126
    v_mfma_f32_16x16x32_bf16 v[100:103], a[88:91], a[40:43], v[100:103]
    ds_read_b128 a[112:115], v32 offset:45056
    v_cvt_pk_bf16_f32 v8, v162, v166
    v_cvt_pk_bf16_f32 v9, v170, v174
    v_mfma_f32_16x16x32_bf16 v[100:103], a[84:87], a[36:39], v[100:103]
    v_exp_f32 v127, v127
    v_mfma_f32_16x16x32_bf16 v[100:103], a[80:83], a[32:35], v[100:103]
    s_waitcnt lgkmcnt(5)
    v_cvt_pk_bf16_f32 v67, v126, v127
    v_cvt_pk_bf16_f32 v10, v178, v182
    v_cvt_pk_bf16_f32 v11, v186, v190
    v_mfma_f32_16x16x32_bf16 v[104:107], a[96:99], a[32:35], v[76:79]
    v_exp_f32 v96, v96
    v_mfma_f32_16x16x32_bf16 v[104:107], a[100:103], a[36:39], v[104:107]
    ds_write_b128 v16, v[8:11] offset:57344
    v_mfma_f32_16x16x32_bf16 v[104:107], a[104:107], a[40:43], v[104:107]
    v_exp_f32 v97, v97
    v_mfma_f32_16x16x32_bf16 v[104:107], a[108:111], a[44:47], v[104:107]
    s_waitcnt lgkmcnt(1)
    v_cvt_pk_bf16_f32 v52, v96, v97
    v_cvt_pk_bf16_f32 v12, v163, v167
    v_cvt_pk_bf16_f32 v13, v171, v175
    v_cvt_pk_bf16_f32 v14, v179, v183
    v_cvt_pk_bf16_f32 v15, v187, v191
    v_mfma_f32_16x16x32_bf16 v[108:111], a[124:127], a[44:47], v[76:79]
    s_barrier
    s_or_b64 vcc, s[66:67], s[68:69]
    v_exp_f32 v98, v98
    v_mfma_f32_16x16x32_bf16 v[108:111], a[120:123], a[40:43], v[108:111]
    s_cbranch_vccnz L_slow
    ds_write_b128 v17, v[12:15] offset:58368
    v_mfma_f32_16x16x32_bf16 v[108:111], a[116:119], a[36:39], v[108:111]
    v_exp_f32 v99, v99
    v_mfma_f32_16x16x32_bf16 v[108:111], a[112:115], a[32:35], v[108:111]
    v_cvt_pk_bf16_f32 v53, v98, v99
    ds_read_b64_tr_b16 v[160:161], v18 offset:49152
    ds_read_b64_tr_b16 v[162:163], v19 offset:49152
    v_smfmac_f32_16x16x64_bf16 v[88:91], v[20:23], v[60:67], v24
    v_mfma_f32_16x16x32_bf16 v[224:227], v[60:63], a[128:131], v[224:227]
    v_exp_f32 v100, v100
    v_mfma_f32_16x16x32_bf16 v[224:227], v[64:67], a[132:135], v[224:227]
    ds_read_b64_tr_b16 v[164:165], v18 offset:49408
    ds_read_b64_tr_b16 v[166:167], v19 offset:49408
    ds_read_b64_tr_b16 v[168:169], v18 offset:49664
    v_mfma_f32_16x16x32_bf16 v[228:231], v[60:63], a[136:139], v[228:231]
    v_exp_f32 v101, v101
    v_mfma_f32_16x16x32_bf16 v[228:231], v[64:67], a[140:143], v[228:231]
    v_cvt_pk_bf16_f32 v54, v100, v101
    ds_read_b64_tr_b16 v[170:171], v19 offset:49664
    ds_read_b64_tr_b16 v[172:173], v18 offset:49920
    ds_read_b64_tr_b16 v[174:175], v19 offset:49920
    v_mfma_f32_16x16x32_bf16 v[232:235], v[60:63], a[144:147], v[232:235]
    v_exp_f32 v102, v102
    v_mfma_f32_16x16x32_bf16 v[232:235], v[64:67], a[148:151], v[232:235]
    s_waitcnt lgkmcnt(6)
    buffer_store_dwordx4 v[160:163], v30, s[28:31], s56 offen sc1
    v_mfma_f32_16x16x32_bf16 v[236:239], v[60:63], a[152:155], v[236:239]
    v_exp_f32 v103, v103
    v_mfma_f32_16x16x32_bf16 v[236:239], v[64:67], a[156:159], v[236:239]
    v_cvt_pk_bf16_f32 v55, v102, v103
    v_mfma_f32_16x16x32_bf16 v[240:243], v[60:63], a[160:163], v[240:243]
    v_exp_f32 v104, v104
    v_mfma_f32_16x16x32_bf16 v[240:243], v[64:67], a[164:167], v[240:243]
    s_waitcnt lgkmcnt(4)
    buffer_store_dwordx4 v[164:167], v30, s[28:31], s56 offen offset:1024 sc1
    v_mfma_f32_16x16x32_bf16 v[244:247], v[60:63], a[168:171], v[244:247]
    v_exp_f32 v105, v105
    v_mfma_f32_16x16x32_bf16 v[244:247], v[64:67], a[172:175], v[244:247]
    v_cvt_pk_bf16_f32 v56, v104, v105
    v_mfma_f32_16x16x32_bf16 v[248:251], v[60:63], a[176:179], v[248:251]
    v_exp_f32 v106, v106
    v_mfma_f32_16x16x32_bf16 v[248:251], v[64:67], a[180:183], v[248:251]
    s_waitcnt lgkmcnt(2)
    buffer_store_dwordx4 v[168:171], v30, s[28:31], s56 offen offset:2048 sc1
    v_mfma_f32_16x16x32_bf16 v[252:255], v[60:63], a[184:187], v[252:255]
    v_exp_f32 v107, v107
    v_mfma_f32_16x16x32_bf16 v[252:255], v[64:67], a[188:191], v[252:255]
    v_cvt_pk_bf16_f32 v57, v106, v107
    v_mfma_f32_16x16x32_bf16 v[112:115], a[64:67], a[48:51], v[80:83]
    v_exp_f32 v108, v108
    v_mfma_f32_16x16x32_bf16 v[112:115], a[68:71], a[52:55], v[112:115]
    s_waitcnt lgkmcnt(0)
    buffer_store_dwordx4 v[172:175], v30, s[28:31], s56 offen offset:3072 sc1
    v_mfma_f32_16x16x32_bf16 v[112:115], a[72:75], a[56:59], v[112:115]
    v_exp_f32 v109, v109
    v_mfma_f32_16x16x32_bf16 v[112:115], a[76:79], a[60:63], v[112:115]
    v_cvt_pk_bf16_f32 v58, v108, v109
    v_mfma_f32_16x16x32_bf16 v[116:119], a[92:95], a[60:63], v[80:83]
    v_exp_f32 v110, v110
    v_mfma_f32_16x16x32_bf16 v[116:119], a[88:91], a[56:59], v[116:119]
    v_mfma_f32_16x16x32_bf16 v[116:119], a[84:87], a[52:55], v[116:119]
    v_exp_f32 v111, v111
    v_mfma_f32_16x16x32_bf16 v[116:119], a[80:83], a[48:51], v[116:119]
    v_cvt_pk_bf16_f32 v59, v110, v111
    v_mfma_f32_16x16x32_bf16 v[120:123], a[96:99], a[48:51], v[80:83]
    v_exp_f32 v112, v112
    v_mfma_f32_16x16x32_bf16 v[120:123], a[100:103], a[52:55], v[120:123]
    v_mfma_f32_16x16x32_bf16 v[120:123], a[104:107], a[56:59], v[120:123]
    v_exp_f32 v113, v113
    v_mfma_f32_16x16x32_bf16 v[120:123], a[108:111], a[60:63], v[120:123]
    v_cvt_pk_bf16_f32 v60, v112, v113
    v_mfma_f32_16x16x32_bf16 v[124:127], a[124:127], a[60:63], v[80:83]
    v_exp_f32 v114, v114
    v_mfma_f32_16x16x32_bf16 v[124:127], a[120:123], a[56:59], v[124:127]
    v_mfma_f32_16x16x32_bf16 v[124:127], a[116:119], a[52:55], v[124:127]
    v_exp_f32 v115, v115
    v_mfma_f32_16x16x32_bf16 v[124:127], a[112:115], a[48:51], v[124:127]
    v_cvt_pk_bf16_f32 v61, v114, v115
    v_smfmac_f32_16x16x64_bf16 v[84:87], v[20:23], v[52:59], v24
    v_mfma_f32_16x16x32_bf16 v[192:195], v[52:55], a[192:195], v[192:195]
    v_exp_f32 v116, v116
    v_mfma_f32_16x16x32_bf16 v[192:195], v[56:59], a[196:199], v[192:195]
    v_mfma_f32_16x16x32_bf16 v[196:199], v[52:55], a[200:203], v[196:199]
    v_exp_f32 v117, v117
    v_mfma_f32_16x16x32_bf16 v[196:199], v[56:59], a[204:207], v[196:199]
    v_cvt_pk_bf16_f32 v62, v116, v117
    v_mfma_f32_16x16x32_bf16 v[200:203], v[52:55], a[208:211], v[200:203]
    v_exp_f32 v118, v118
    v_mfma_f32_16x16x32_bf16 v[200:203], v[56:59], a[212:215], v[200:203]
    v_mfma_f32_16x16x32_bf16 v[204:207], v[52:55], a[216:219], v[204:207]
    v_exp_f32 v119, v119
    v_mfma_f32_16x16x32_bf16 v[204:207], v[56:59], a[220:223], v[204:207]
    v_cvt_pk_bf16_f32 v63, v118, v119
    v_add_f32 v92, v84, v85
    v_cmp_ngt_f32 vcc, s59, v92
    v_mfma_f32_16x16x32_bf16 v[208:211], v[52:55], a[224:227], v[208:211]
    v_exp_f32 v120, v120
    v_mfma_f32_16x16x32_bf16 v[208:211], v[56:59], a[228:231], v[208:211]
    v_rcp_f32 v92, v92
    v_mfma_f32_16x16x32_bf16 v[212:215], v[52:55], a[232:235], v[212:215]
    v_exp_f32 v121, v121
    v_mfma_f32_16x16x32_bf16 v[212:215], v[56:59], a[236:239], v[212:215]
    v_cvt_pk_bf16_f32 v64, v120, v121
    ds_bpermute_b32 v84, v31, v92 offset:0
    v_mfma_f32_16x16x32_bf16 v[216:219], v[52:55], a[240:243], v[216:219]
    v_exp_f32 v122, v122
    v_mfma_f32_16x16x32_bf16 v[216:219], v[56:59], a[244:247], v[216:219]
    ds_bpermute_b32 v85, v31, v92 offset:4
    ds_bpermute_b32 v86, v31, v92 offset:8
    v_mfma_f32_16x16x32_bf16 v[220:223], v[52:55], a[248:251], v[220:223]
    v_exp_f32 v123, v123
    v_mfma_f32_16x16x32_bf16 v[220:223], v[56:59], a[252:255], v[220:223]
    v_cvt_pk_bf16_f32 v65, v122, v123
    ds_bpermute_b32 v87, v31, v92 offset:12
    v_exp_f32 v124, v124
    v_exp_f32 v125, v125
    v_exp_f32 v126, v126
    v_cvt_pk_bf16_f32 v66, v124, v125
    v_exp_f32 v127, v127
    s_nop 0
    v_cvt_pk_bf16_f32 v67, v126, v127
    s_cbranch_vccnz L_slow
    s_waitcnt lgkmcnt(0)
    v_pk_mul_f32 v[192:193], v[192:193], v[84:85]
    v_pk_mul_f32 v[196:197], v[196:197], v[84:85]
    v_pk_mul_f32 v[200:201], v[200:201], v[84:85]
    v_pk_mul_f32 v[204:205], v[204:205], v[84:85]
    v_pk_mul_f32 v[208:209], v[208:209], v[84:85]
    v_pk_mul_f32 v[212:213], v[212:213], v[84:85]
    v_pk_mul_f32 v[216:217], v[216:217], v[84:85]
    v_pk_mul_f32 v[220:221], v[220:221], v[84:85]
    v_pk_mul_f32 v[194:195], v[194:195], v[86:87]
    v_pk_mul_f32 v[198:199], v[198:199], v[86:87]
    v_pk_mul_f32 v[202:203], v[202:203], v[86:87]
    v_pk_mul_f32 v[206:207], v[206:207], v[86:87]
    v_pk_mul_f32 v[210:211], v[210:211], v[86:87]
    v_pk_mul_f32 v[214:215], v[214:215], v[86:87]
    v_pk_mul_f32 v[218:219], v[218:219], v[86:87]
    v_pk_mul_f32 v[222:223], v[222:223], v[86:87]
    v_smfmac_f32_16x16x64_bf16 v[88:91], v[20:23], v[60:67], v24
    v_cvt_pk_bf16_f32 v0, v192, v196
    v_cvt_pk_bf16_f32 v1, v200, v204
    v_mfma_f32_16x16x32_bf16 v[224:227], v[60:63], a[192:195], v[224:227]
    v_cvt_pk_bf16_f32 v2, v208, v212
    v_cvt_pk_bf16_f32 v3, v216, v220
    v_mfma_f32_16x16x32_bf16 v[224:227], v[64:67], a[196:199], v[224:227]
    ds_write_b128 v16, v[0:3] offset:0
    v_cvt_pk_bf16_f32 v4, v193, v197
    v_mfma_f32_16x16x32_bf16 v[228:231], v[60:63], a[200:203], v[228:231]
    v_cvt_pk_bf16_f32 v5, v201, v205
    v_cvt_pk_bf16_f32 v6, v209, v213
    v_mfma_f32_16x16x32_bf16 v[228:231], v[64:67], a[204:207], v[228:231]
    v_cvt_pk_bf16_f32 v7, v217, v221
    ds_write_b128 v17, v[4:7] offset:1024
    v_mfma_f32_16x16x32_bf16 v[232:235], v[60:63], a[208:211], v[232:235]
    v_cvt_pk_bf16_f32 v8, v194, v198
    v_cvt_pk_bf16_f32 v9, v202, v206
    v_mfma_f32_16x16x32_bf16 v[232:235], v[64:67], a[212:215], v[232:235]
    v_cvt_pk_bf16_f32 v10, v210, v214
    v_cvt_pk_bf16_f32 v11, v218, v222
    v_mfma_f32_16x16x32_bf16 v[236:239], v[60:63], a[216:219], v[236:239]
    ds_write_b128 v16, v[8:11] offset:8192
    v_add_f32 v92, v88, v89
    v_mfma_f32_16x16x32_bf16 v[236:239], v[64:67], a[220:223], v[236:239]
    v_cmp_ngt_f32 vcc, s59, v92
    v_cvt_pk_bf16_f32 v12, v195, v199
    v_mfma_f32_16x16x32_bf16 v[240:243], v[60:63], a[224:227], v[240:243]
    v_cvt_pk_bf16_f32 v13, v203, v207
    v_cvt_pk_bf16_f32 v14, v211, v215
    v_mfma_f32_16x16x32_bf16 v[240:243], v[64:67], a[228:231], v[240:243]
    v_rcp_f32 v92, v92
    v_cvt_pk_bf16_f32 v15, v219, v223
    v_mfma_f32_16x16x32_bf16 v[244:247], v[60:63], a[232:235], v[244:247]
    ds_write_b128 v17, v[12:15] offset:9216
    ds_bpermute_b32 v88, v31, v92 offset:0
    v_mfma_f32_16x16x32_bf16 v[244:247], v[64:67], a[236:239], v[244:247]
    ds_bpermute_b32 v89, v31, v92 offset:4
    ds_bpermute_b32 v90, v31, v92 offset:8
    v_mfma_f32_16x16x32_bf16 v[248:251], v[60:63], a[240:243], v[248:251]
    ds_bpermute_b32 v91, v31, v92 offset:12
    ds_read_b64_tr_b16 v[192:193], v18 offset:0
    v_mfma_f32_16x16x32_bf16 v[248:251], v[64:67], a[244:247], v[248:251]
    ds_read_b64_tr_b16 v[194:195], v19 offset:0
    ds_read_b64_tr_b16 v[196:197], v18 offset:256
    v_mfma_f32_16x16x32_bf16 v[252:255], v[60:63], a[248:251], v[252:255]
    ds_read_b64_tr_b16 v[198:199], v19 offset:256
    ds_read_b64_tr_b16 v[200:201], v18 offset:512
    v_mfma_f32_16x16x32_bf16 v[252:255], v[64:67], a[252:255], v[252:255]
    ds_read_b64_tr_b16 v[202:203], v19 offset:512
    ds_read_b64_tr_b16 v[204:205], v18 offset:768
    ds_read_b64_tr_b16 v[206:207], v19 offset:768
    s_waitcnt lgkmcnt(6)
    buffer_store_dwordx4 v[192:195], v30, s[28:31], s57 offen sc1
    s_waitcnt lgkmcnt(4)
    buffer_store_dwordx4 v[196:199], v30, s[28:31], s57 offen offset:1024 sc1
    s_cbranch_vccnz L_slow
    s_waitcnt lgkmcnt(2)
    buffer_store_dwordx4 v[200:203], v30, s[28:31], s57 offen offset:2048 sc1
    s_waitcnt lgkmcnt(0)
    buffer_store_dwordx4 v[204:207], v30, s[28:31], s57 offen offset:3072 sc1
    v_pk_mul_f32 v[224:225], v[224:225], v[88:89]
    v_pk_mul_f32 v[228:229], v[228:229], v[88:89]
    v_pk_mul_f32 v[232:233], v[232:233], v[88:89]
    v_pk_mul_f32 v[236:237], v[236:237], v[88:89]
    v_pk_mul_f32 v[240:241], v[240:241], v[88:89]
    v_pk_mul_f32 v[244:245], v[244:245], v[88:89]
    v_pk_mul_f32 v[248:249], v[248:249], v[88:89]
    v_pk_mul_f32 v[252:253], v[252:253], v[88:89]
    v_pk_mul_f32 v[226:227], v[226:227], v[90:91]
    v_pk_mul_f32 v[230:231], v[230:231], v[90:91]
    v_pk_mul_f32 v[234:235], v[234:235], v[90:91]
    v_pk_mul_f32 v[238:239], v[238:239], v[90:91]
    v_pk_mul_f32 v[242:243], v[242:243], v[90:91]
    v_pk_mul_f32 v[246:247], v[246:247], v[90:91]
    v_pk_mul_f32 v[250:251], v[250:251], v[90:91]
    v_pk_mul_f32 v[254:255], v[254:255], v[90:91]
    v_cvt_pk_bf16_f32 v0, v224, v228
    v_cvt_pk_bf16_f32 v1, v232, v236
    v_cvt_pk_bf16_f32 v2, v240, v244
    v_cvt_pk_bf16_f32 v3, v248, v252
    ds_write_b128 v16, v[0:3] offset:49152
    v_cvt_pk_bf16_f32 v4, v225, v229
    v_cvt_pk_bf16_f32 v5, v233, v237
    v_cvt_pk_bf16_f32 v6, v241, v245
    v_cvt_pk_bf16_f32 v7, v249, v253
    ds_write_b128 v17, v[4:7] offset:50176
    v_cvt_pk_bf16_f32 v8, v226, v230
    v_cvt_pk_bf16_f32 v9, v234, v238
    v_cvt_pk_bf16_f32 v10, v242, v246
    v_cvt_pk_bf16_f32 v11, v250, v254
    ds_write_b128 v16, v[8:11] offset:57344
    v_cvt_pk_bf16_f32 v12, v227, v231
    v_cvt_pk_bf16_f32 v13, v235, v239
    v_cvt_pk_bf16_f32 v14, v243, v247
    v_cvt_pk_bf16_f32 v15, v251, v255
    ds_write_b128 v17, v[12:15] offset:58368
    ds_read_b64_tr_b16 v[224:225], v18 offset:49152
    ds_read_b64_tr_b16 v[226:227], v19 offset:49152
    ds_read_b64_tr_b16 v[228:229], v18 offset:49408
    ds_read_b64_tr_b16 v[230:231], v19 offset:49408
    ds_read_b64_tr_b16 v[232:233], v18 offset:49664
    ds_read_b64_tr_b16 v[234:235], v19 offset:49664
    ds_read_b64_tr_b16 v[236:237], v18 offset:49920
    ds_read_b64_tr_b16 v[238:239], v19 offset:49920
    s_waitcnt lgkmcnt(6)
    buffer_store_dwordx4 v[224:227], v30, s[28:31], s58 offen sc1
    s_waitcnt lgkmcnt(4)
    buffer_store_dwordx4 v[228:231], v30, s[28:31], s58 offen offset:1024 sc1
    s_waitcnt lgkmcnt(2)
    buffer_store_dwordx4 v[232:235], v30, s[28:31], s58 offen offset:2048 sc1
    s_waitcnt lgkmcnt(0)
    buffer_store_dwordx4 v[236:239], v30, s[28:31], s58 offen offset:3072 sc1
L_end:
    s_endpgm
L_slow:
    s_waitcnt vmcnt(0) lgkmcnt(0)
    s_nop 15
    v_mov_b32 v128, 0
    v_mov_b32 v129, 0
    v_mov_b32 v130, 0
    v_mov_b32 v131, 0
    v_mov_b32 v132, 0
    v_mov_b32 v133, 0
    v_mov_b32 v134, 0
    v_mov_b32 v135, 0
    v_mov_b32 v136, 0
    v_mov_b32 v137, 0
    v_mov_b32 v138, 0
    v_mov_b32 v139, 0
    v_mov_b32 v140, 0
    v_mov_b32 v141, 0
    v_mov_b32 v142, 0
    v_mov_b32 v143, 0
    v_mov_b32 v144, 0
    v_mov_b32 v145, 0
    v_mov_b32 v146, 0
    v_mov_b32 v147, 0
    v_mov_b32 v148, 0
    v_mov_b32 v149, 0
    v_mov_b32 v150, 0
    v_mov_b32 v151, 0
    v_mov_b32 v152, 0
    v_mov_b32 v153, 0
    v_mov_b32 v154, 0
    v_mov_b32 v155, 0
    v_mov_b32 v156, 0
    v_mov_b32 v157, 0
    v_mov_b32 v158, 0
    v_mov_b32 v159, 0
    v_mov_b32 v160, 0
    v_mov_b32 v161, 0
    v_mov_b32 v162, 0
    v_mov_b32 v163, 0
    v_mov_b32 v164, 0
    v_mov_b32 v165, 0
    v_mov_b32 v166, 0
    v_mov_b32 v167, 0
    v_mov_b32 v168, 0
    v_mov_b32 v169, 0
    v_mov_b32 v170, 0
    v_mov_b32 v171, 0
    v_mov_b32 v172, 0
    v_mov_b32 v173, 0
    v_mov_b32 v174, 0
    v_mov_b32 v175, 0
    v_mov_b32 v176, 0
    v_mov_b32 v177, 0
    v_mov_b32 v178, 0
    v_mov_b32 v179, 0
    v_mov_b32 v180, 0
    v_mov_b32 v181, 0
    v_mov_b32 v182, 0
    v_mov_b32 v183, 0
    v_mov_b32 v184, 0
    v_mov_b32 v185, 0
    v_mov_b32 v186, 0
    v_mov_b32 v187, 0
    v_mov_b32 v188, 0
    v_mov_b32 v189, 0
    v_mov_b32 v190, 0
    v_mov_b32 v191, 0
    v_mov_b32 v192, 0
    v_mov_b32 v193, 0
    v_mov_b32 v194, 0
    v_mov_b32 v195, 0
    v_mov_b32 v196, 0
    v_mov_b32 v197, 0
    v_mov_b32 v198, 0
    v_mov_b32 v199, 0
    v_mov_b32 v200, 0
    v_mov_b32 v201, 0
    v_mov_b32 v202, 0
    v_mov_b32 v203, 0
    v_mov_b32 v204, 0
    v_mov_b32 v205, 0
    v_mov_b32 v206, 0
    v_mov_b32 v207, 0
    v_mov_b32 v208, 0
    v_mov_b32 v209, 0
    v_mov_b32 v210, 0
    v_mov_b32 v211, 0
    v_mov_b32 v212, 0
    v_mov_b32 v213, 0
    v_mov_b32 v214, 0
    v_mov_b32 v215, 0
    v_mov_b32 v216, 0
    v_mov_b32 v217, 0
    v_mov_b32 v218, 0
    v_mov_b32 v219, 0
    v_mov_b32 v220, 0
    v_mov_b32 v221, 0
    v_mov_b32 v222, 0
    v_mov_b32 v223, 0
    v_mov_b32 v224, 0
    v_mov_b32 v225, 0
    v_mov_b32 v226, 0
    v_mov_b32 v227, 0
    v_mov_b32 v228, 0
    v_mov_b32 v229, 0
    v_mov_b32 v230, 0
    v_mov_b32 v231, 0
    v_mov_b32 v232, 0
    v_mov_b32 v233, 0
    v_mov_b32 v234, 0
    v_mov_b32 v235, 0
    v_mov_b32 v236, 0
    v_mov_b32 v237, 0
    v_mov_b32 v238, 0
    v_mov_b32 v239, 0
    v_mov_b32 v240, 0
    v_mov_b32 v241, 0
    v_mov_b32 v242, 0
    v_mov_b32 v243, 0
    v_mov_b32 v244, 0
    v_mov_b32 v245, 0
    v_mov_b32 v246, 0
    v_mov_b32 v247, 0
    v_mov_b32 v248, 0
    v_mov_b32 v249, 0
    v_mov_b32 v250, 0
    v_mov_b32 v251, 0
    v_mov_b32 v252, 0
    v_mov_b32 v253, 0
    v_mov_b32 v254, 0
    v_mov_b32 v255, 0
    v_mov_b32 v44, 0
    v_mov_b32 v45, 0
    v_mov_b32 v46, 0
    v_mov_b32 v47, 0
    v_mov_b32 v68, 0xff7fffff
    v_mov_b32 v48, 0
    v_mov_b32 v49, 0
    v_mov_b32 v50, 0
    v_mov_b32 v51, 0
    v_mov_b32 v69, 0xff7fffff
    v_mov_b32 v84, 0
    v_mov_b32 v85, 0
    v_mov_b32 v86, 0
    v_mov_b32 v87, 0
    v_mov_b32 v70, 0xff7fffff
    v_mov_b32 v88, 0
    v_mov_b32 v89, 0
    v_mov_b32 v90, 0
    v_mov_b32 v91, 0
    v_mov_b32 v71, 0xff7fffff
    v_lshrrev_b32 v2, 4, v25
    v_and_b32 v3, 15, v25
    v_xor_b32 v4, v3, v2
    v_lshlrev_b32 v4, 4, v4
    v_lshl_add_u32 v80, v2, 8, v4
    v_xor_b32 v81, 64, v80
    v_xor_b32 v82, 128, v80
    v_xor_b32 v83, 192, v80
    v_mov_b32 v72, v80
    v_xor_b32 v73, 0x80, v80
    v_lshrrev_b32 v5, 3, v3
    v_mul_u32_u24 v5, 6144, v5
    v_add_u32 v5, s36, v5
    v_and_b32 v32, 0xfff, v32
    v_add_u32 v32, v32, v5
    v_and_b32 v33, 0xfff, v33
    v_add_u32 v33, v33, v5
    v_and_b32 v34, 0xfff, v34
    v_add_u32 v34, v34, v5
    v_and_b32 v35, 0xfff, v35
    v_add_u32 v35, v35, v5
    v_lshrrev_b32 v5, 5, v25
    v_mul_u32_u24 v5, 6144, v5
    v_add_u32 v5, s36, v5
    v_add_u32 v5, 65536, v5
    v_and_b32 v36, 0xfff, v36
    v_add_u32 v36, v36, v5
    v_and_b32 v37, 0xfff, v37
    v_add_u32 v37, v37, v5
    v_and_b32 v38, 0xfff, v38
    v_add_u32 v38, v38, v5
    v_and_b32 v39, 0xfff, v39
    v_add_u32 v39, v39, v5
    v_and_b32 v40, 0xfff, v40
    v_add_u32 v40, v40, v5
    v_and_b32 v41, 0xfff, v41
    v_add_u32 v41, v41, v5
    v_and_b32 v42, 0xfff, v42
    v_add_u32 v42, v42, v5
    v_and_b32 v43, 0xfff, v43
    v_add_u32 v43, v43, v5
    s_mov_b32 s33, 0
L_slow_loop:
    s_add_u32 m0, s36, 0
    s_add_u32 s38, s33, 0
    buffer_load_dwordx4 v80, s[20:23], s38 offen nt lds
    buffer_load_dwordx4 v81, s[20:23], s38 offen offset:1024 nt lds
    s_add_u32 m0, s36, 65536
    s_nop 0
    buffer_load_dwordx4 v72, s[24:27], s38 offen nt lds
    buffer_load_dwordx4 v73, s[24:27], s38 offen offset:1024 nt lds
    s_add_u32 m0, s36, 8192
    s_add_u32 s38, s33, 2048
    buffer_load_dwordx4 v82, s[20:23], s38 offen nt lds
    buffer_load_dwordx4 v83, s[20:23], s38 offen offset:1024 nt lds
    s_add_u32 m0, s36, 73728
    s_nop 0
    buffer_load_dwordx4 v72, s[24:27], s38 offen nt lds
    buffer_load_dwordx4 v73, s[24:27], s38 offen offset:1024 nt lds
    s_add_u32 m0, s36, 16384
    s_add_u32 s38, s33, 4096
    buffer_load_dwordx4 v80, s[20:23], s38 offen nt lds
    buffer_load_dwordx4 v81, s[20:23], s38 offen offset:1024 nt lds
    s_add_u32 m0, s36, 81920
    s_nop 0
    buffer_load_dwordx4 v72, s[24:27], s38 offen nt lds
    buffer_load_dwordx4 v73, s[24:27], s38 offen offset:1024 nt lds
    s_add_u32 m0, s36, 24576
    s_add_u32 s38, s33, 6144
    buffer_load_dwordx4 v82, s[20:23], s38 offen nt lds
    buffer_load_dwordx4 v83, s[20:23], s38 offen offset:1024 nt lds
    s_add_u32 m0, s36, 90112
    s_nop 0
    buffer_load_dwordx4 v72, s[24:27], s38 offen nt lds
    buffer_load_dwordx4 v73, s[24:27], s38 offen offset:1024 nt lds
    s_add_u32 m0, s36, 32768
    s_add_u32 s38, s33, 8192
    buffer_load_dwordx4 v80, s[20:23], s38 offen nt lds
    buffer_load_dwordx4 v81, s[20:23], s38 offen offset:1024 nt lds
    s_add_u32 m0, s36, 98304
    s_nop 0
    buffer_load_dwordx4 v72, s[24:27], s38 offen nt lds
    buffer_load_dwordx4 v73, s[24:27], s38 offen offset:1024 nt lds
    s_add_u32 m0, s36, 40960
    s_add_u32 s38, s33, 10240
    buffer_load_dwordx4 v82, s[20:23], s38 offen nt lds
    buffer_load_dwordx4 v83, s[20:23], s38 offen offset:1024 nt lds
    s_add_u32 m0, s36, 106496
    s_nop 0
    buffer_load_dwordx4 v72, s[24:27], s38 offen nt lds
    buffer_load_dwordx4 v73, s[24:27], s38 offen offset:1024 nt lds
    s_add_u32 m0, s36, 49152
    s_add_u32 s38, s33, 12288
    buffer_load_dwordx4 v80, s[20:23], s38 offen nt lds
    buffer_load_dwordx4 v81, s[20:23], s38 offen offset:1024 nt lds
    s_add_u32 m0, s36, 114688
    s_nop 0
    buffer_load_dwordx4 v72, s[24:27], s38 offen nt lds
    buffer_load_dwordx4 v73, s[24:27], s38 offen offset:1024 nt lds
    s_add_u32 m0, s36, 57344
    s_add_u32 s38, s33, 14336
    buffer_load_dwordx4 v82, s[20:23], s38 offen nt lds
    buffer_load_dwordx4 v83, s[20:23], s38 offen offset:1024 nt lds
    s_add_u32 m0, s36, 122880
    s_nop 0
    buffer_load_dwordx4 v72, s[24:27], s38 offen nt lds
    buffer_load_dwordx4 v73, s[24:27], s38 offen offset:1024 nt lds
    s_waitcnt vmcnt(0)
    ds_read_b128 a[64:67], v32 offset:0
    ds_read_b128 a[68:71], v33 offset:0
    ds_read_b128 a[72:75], v34 offset:0
    ds_read_b128 a[76:79], v35 offset:0
    ds_read_b128 a[80:83], v32 offset:16384
    ds_read_b128 a[84:87], v33 offset:16384
    ds_read_b128 a[88:91], v34 offset:16384
    ds_read_b128 a[92:95], v35 offset:16384
    s_waitcnt lgkmcnt(0)
    ds_read_b128 a[96:99], v32 offset:32768
    ds_read_b128 a[100:103], v33 offset:32768
    ds_read_b128 a[104:107], v34 offset:32768
    ds_read_b128 a[108:111], v35 offset:32768
    ds_read_b128 a[112:115], v32 offset:49152
    ds_read_b128 a[116:119], v33 offset:49152
    ds_read_b128 a[120:123], v34 offset:49152
    ds_read_b128 a[124:127], v35 offset:49152
    s_waitcnt lgkmcnt(0)
    ds_read_b64_tr_b16 a[128:129], v36 offset:0
    ds_read_b64_tr_b16 a[130:131], v36 offset:16384
    ds_read_b64_tr_b16 a[132:133], v36 offset:32768
    ds_read_b64_tr_b16 a[134:135], v36 offset:49152
    ds_read_b64_tr_b16 a[136:137], v37 offset:0
    ds_read_b64_tr_b16 a[138:139], v37 offset:16384
    ds_read_b64_tr_b16 a[140:141], v37 offset:32768
    ds_read_b64_tr_b16 a[142:143], v37 offset:49152
    s_waitcnt lgkmcnt(0)
    ds_read_b64_tr_b16 a[144:145], v38 offset:0
    ds_read_b64_tr_b16 a[146:147], v38 offset:16384
    ds_read_b64_tr_b16 a[148:149], v38 offset:32768
    ds_read_b64_tr_b16 a[150:151], v38 offset:49152
    ds_read_b64_tr_b16 a[152:153], v39 offset:0
    ds_read_b64_tr_b16 a[154:155], v39 offset:16384
    ds_read_b64_tr_b16 a[156:157], v39 offset:32768
    ds_read_b64_tr_b16 a[158:159], v39 offset:49152
    s_waitcnt lgkmcnt(0)
    ds_read_b64_tr_b16 a[160:161], v40 offset:0
    ds_read_b64_tr_b16 a[162:163], v40 offset:16384
    ds_read_b64_tr_b16 a[164:165], v40 offset:32768
    ds_read_b64_tr_b16 a[166:167], v40 offset:49152
    ds_read_b64_tr_b16 a[168:169], v41 offset:0
    ds_read_b64_tr_b16 a[170:171], v41 offset:16384
    ds_read_b64_tr_b16 a[172:173], v41 offset:32768
    ds_read_b64_tr_b16 a[174:175], v41 offset:49152
    s_waitcnt lgkmcnt(0)
    ds_read_b64_tr_b16 a[176:177], v42 offset:0
    ds_read_b64_tr_b16 a[178:179], v42 offset:16384
    ds_read_b64_tr_b16 a[180:181], v42 offset:32768
    ds_read_b64_tr_b16 a[182:183], v42 offset:49152
    ds_read_b64_tr_b16 a[184:185], v43 offset:0
    ds_read_b64_tr_b16 a[186:187], v43 offset:16384
    ds_read_b64_tr_b16 a[188:189], v43 offset:32768
    ds_read_b64_tr_b16 a[190:191], v43 offset:49152
    s_waitcnt lgkmcnt(0)
    v_mfma_f32_16x16x32_bf16 v[96:99], a[64:67], a[0:3], 0
    v_mfma_f32_16x16x32_bf16 v[96:99], a[68:71], a[4:7], v[96:99]
    v_mfma_f32_16x16x32_bf16 v[96:99], a[72:75], a[8:11], v[96:99]
    v_mfma_f32_16x16x32_bf16 v[96:99], a[76:79], a[12:15], v[96:99]
    v_mfma_f32_16x16x32_bf16 v[100:103], a[92:95], a[12:15], 0
    v_mfma_f32_16x16x32_bf16 v[100:103], a[88:91], a[8:11], v[100:103]
    v_mfma_f32_16x16x32_bf16 v[100:103], a[84:87], a[4:7], v[100:103]
    v_mfma_f32_16x16x32_bf16 v[100:103], a[80:83], a[0:3], v[100:103]
    v_mfma_f32_16x16x32_bf16 v[104:107], a[96:99], a[0:3], 0
    v_mfma_f32_16x16x32_bf16 v[104:107], a[100:103], a[4:7], v[104:107]
    v_mfma_f32_16x16x32_bf16 v[104:107], a[104:107], a[8:11], v[104:107]
    v_mfma_f32_16x16x32_bf16 v[104:107], a[108:111], a[12:15], v[104:107]
    v_mfma_f32_16x16x32_bf16 v[108:111], a[124:127], a[12:15], 0
    v_mfma_f32_16x16x32_bf16 v[108:111], a[120:123], a[8:11], v[108:111]
    v_mfma_f32_16x16x32_bf16 v[108:111], a[116:119], a[4:7], v[108:111]
    v_mfma_f32_16x16x32_bf16 v[108:111], a[112:115], a[0:3], v[108:111]
    s_nop 15
    v_max3_f32 v0, v96, v97, v98
    v_max3_f32 v1, v99, v100, v101
    v_max3_f32 v0, v0, v102, v103
    v_max3_f32 v1, v1, v104, v105
    v_max3_f32 v0, v0, v106, v107
    v_max3_f32 v1, v1, v108, v109
    v_max3_f32 v0, v0, v110, v111
    v_max_f32 v0, v0, v1
    v_mov_b32 v1, v0
    s_nop 1
    v_permlane16_swap_b32 v0, v1
    v_max_f32 v0, v0, v1
    v_mov_b32 v1, v0
    s_nop 1
    v_permlane32_swap_b32 v0, v1
    v_max_f32 v0, v0, v1
    v_max_f32 v0, v0, v68
    v_sub_f32 v1, v68, v0
    v_exp_f32 v1, v1
    v_mov_b32 v68, v0
    ds_bpermute_b32 v76, v31, v1 offset:0
    ds_bpermute_b32 v77, v31, v1 offset:4
    ds_bpermute_b32 v78, v31, v1 offset:8
    ds_bpermute_b32 v79, v31, v1 offset:12
    v_mul_f32 v44, v44, v1
    v_mul_f32 v45, v45, v1
    v_sub_f32 v96, v96, v0
    v_sub_f32 v97, v97, v0
    v_sub_f32 v98, v98, v0
    v_sub_f32 v99, v99, v0
    v_sub_f32 v100, v100, v0
    v_sub_f32 v101, v101, v0
    v_sub_f32 v102, v102, v0
    v_sub_f32 v103, v103, v0
    v_sub_f32 v104, v104, v0
    v_sub_f32 v105, v105, v0
    v_sub_f32 v106, v106, v0
    v_sub_f32 v107, v107, v0
    v_sub_f32 v108, v108, v0
    v_sub_f32 v109, v109, v0
    v_sub_f32 v110, v110, v0
    v_sub_f32 v111, v111, v0
    v_exp_f32 v96, v96
    v_exp_f32 v97, v97
    v_exp_f32 v98, v98
    v_cvt_pk_bf16_f32 v52, v96, v97
    v_exp_f32 v99, v99
    v_exp_f32 v100, v100
    v_cvt_pk_bf16_f32 v53, v98, v99
    v_exp_f32 v101, v101
    v_exp_f32 v102, v102
    v_cvt_pk_bf16_f32 v54, v100, v101
    v_exp_f32 v103, v103
    v_exp_f32 v104, v104
    v_cvt_pk_bf16_f32 v55, v102, v103
    v_exp_f32 v105, v105
    v_exp_f32 v106, v106
    v_cvt_pk_bf16_f32 v56, v104, v105
    v_exp_f32 v107, v107
    v_exp_f32 v108, v108
    v_cvt_pk_bf16_f32 v57, v106, v107
    v_exp_f32 v109, v109
    v_exp_f32 v110, v110
    v_cvt_pk_bf16_f32 v58, v108, v109
    v_exp_f32 v111, v111
    s_nop 0
    v_cvt_pk_bf16_f32 v59, v110, v111
    s_waitcnt lgkmcnt(0)
    v_mul_f32 v128, v128, v76
    v_mul_f32 v129, v129, v77
    v_mul_f32 v130, v130, v78
    v_mul_f32 v131, v131, v79
    v_mul_f32 v132, v132, v76
    v_mul_f32 v133, v133, v77
    v_mul_f32 v134, v134, v78
    v_mul_f32 v135, v135, v79
    v_mul_f32 v136, v136, v76
    v_mul_f32 v137, v137, v77
    v_mul_f32 v138, v138, v78
    v_mul_f32 v139, v139, v79
    v_mul_f32 v140, v140, v76
    v_mul_f32 v141, v141, v77
    v_mul_f32 v142, v142, v78
    v_mul_f32 v143, v143, v79
    v_mul_f32 v144, v144, v76
    v_mul_f32 v145, v145, v77
    v_mul_f32 v146, v146, v78
    v_mul_f32 v147, v147, v79
    v_mul_f32 v148, v148, v76
    v_mul_f32 v149, v149, v77
    v_mul_f32 v150, v150, v78
    v_mul_f32 v151, v151, v79
    v_mul_f32 v152, v152, v76
    v_mul_f32 v153, v153, v77
    v_mul_f32 v154, v154, v78
    v_mul_f32 v155, v155, v79
    v_mul_f32 v156, v156, v76
    v_mul_f32 v157, v157, v77
    v_mul_f32 v158, v158, v78
    v_mul_f32 v159, v159, v79
    s_nop 1
    v_smfmac_f32_16x16x64_bf16 v[44:47], v[20:23], v[52:59], v24
    v_mfma_f32_16x16x32_bf16 v[128:131], v[52:55], a[128:131], v[128:131]
    v_mfma_f32_16x16x32_bf16 v[128:131], v[56:59], a[132:135], v[128:131]
    v_mfma_f32_16x16x32_bf16 v[132:135], v[52:55], a[136:139], v[132:135]
    v_mfma_f32_16x16x32_bf16 v[132:135], v[56:59], a[140:143], v[132:135]
    v_mfma_f32_16x16x32_bf16 v[136:139], v[52:55], a[144:147], v[136:139]
    v_mfma_f32_16x16x32_bf16 v[136:139], v[56:59], a[148:151], v[136:139]
    v_mfma_f32_16x16x32_bf16 v[140:143], v[52:55], a[152:155], v[140:143]
    v_mfma_f32_16x16x32_bf16 v[140:143], v[56:59], a[156:159], v[140:143]
    v_mfma_f32_16x16x32_bf16 v[144:147], v[52:55], a[160:163], v[144:147]
    v_mfma_f32_16x16x32_bf16 v[144:147], v[56:59], a[164:167], v[144:147]
    v_mfma_f32_16x16x32_bf16 v[148:151], v[52:55], a[168:171], v[148:151]
    v_mfma_f32_16x16x32_bf16 v[148:151], v[56:59], a[172:175], v[148:151]
    v_mfma_f32_16x16x32_bf16 v[152:155], v[52:55], a[176:179], v[152:155]
    v_mfma_f32_16x16x32_bf16 v[152:155], v[56:59], a[180:183], v[152:155]
    v_mfma_f32_16x16x32_bf16 v[156:159], v[52:55], a[184:187], v[156:159]
    v_mfma_f32_16x16x32_bf16 v[156:159], v[56:59], a[188:191], v[156:159]
    v_mfma_f32_16x16x32_bf16 v[112:115], a[64:67], a[16:19], 0
    v_mfma_f32_16x16x32_bf16 v[112:115], a[68:71], a[20:23], v[112:115]
    v_mfma_f32_16x16x32_bf16 v[112:115], a[72:75], a[24:27], v[112:115]
    v_mfma_f32_16x16x32_bf16 v[112:115], a[76:79], a[28:31], v[112:115]
    v_mfma_f32_16x16x32_bf16 v[116:119], a[92:95], a[28:31], 0
    v_mfma_f32_16x16x32_bf16 v[116:119], a[88:91], a[24:27], v[116:119]
    v_mfma_f32_16x16x32_bf16 v[116:119], a[84:87], a[20:23], v[116:119]
    v_mfma_f32_16x16x32_bf16 v[116:119], a[80:83], a[16:19], v[116:119]
    v_mfma_f32_16x16x32_bf16 v[120:123], a[96:99], a[16:19], 0
    v_mfma_f32_16x16x32_bf16 v[120:123], a[100:103], a[20:23], v[120:123]
    v_mfma_f32_16x16x32_bf16 v[120:123], a[104:107], a[24:27], v[120:123]
    v_mfma_f32_16x16x32_bf16 v[120:123], a[108:111], a[28:31], v[120:123]
    v_mfma_f32_16x16x32_bf16 v[124:127], a[124:127], a[28:31], 0
    v_mfma_f32_16x16x32_bf16 v[124:127], a[120:123], a[24:27], v[124:127]
    v_mfma_f32_16x16x32_bf16 v[124:127], a[116:119], a[20:23], v[124:127]
    v_mfma_f32_16x16x32_bf16 v[124:127], a[112:115], a[16:19], v[124:127]
    s_nop 15
    v_max3_f32 v0, v112, v113, v114
    v_max3_f32 v1, v115, v116, v117
    v_max3_f32 v0, v0, v118, v119
    v_max3_f32 v1, v1, v120, v121
    v_max3_f32 v0, v0, v122, v123
    v_max3_f32 v1, v1, v124, v125
    v_max3_f32 v0, v0, v126, v127
    v_max_f32 v0, v0, v1
    v_mov_b32 v1, v0
    s_nop 1
    v_permlane16_swap_b32 v0, v1
    v_max_f32 v0, v0, v1
    v_mov_b32 v1, v0
    s_nop 1
    v_permlane32_swap_b32 v0, v1
    v_max_f32 v0, v0, v1
    v_max_f32 v0, v0, v69
    v_sub_f32 v1, v69, v0
    v_exp_f32 v1, v1
    v_mov_b32 v69, v0
    ds_bpermute_b32 v76, v31, v1 offset:0
    ds_bpermute_b32 v77, v31, v1 offset:4
    ds_bpermute_b32 v78, v31, v1 offset:8
    ds_bpermute_b32 v79, v31, v1 offset:12
    v_mul_f32 v48, v48, v1
    v_mul_f32 v49, v49, v1
    v_sub_f32 v112, v112, v0
    v_sub_f32 v113, v113, v0
    v_sub_f32 v114, v114, v0
    v_sub_f32 v115, v115, v0
    v_sub_f32 v116, v116, v0
    v_sub_f32 v117, v117, v0
    v_sub_f32 v118, v118, v0
    v_sub_f32 v119, v119, v0
    v_sub_f32 v120, v120, v0
    v_sub_f32 v121, v121, v0
    v_sub_f32 v122, v122, v0
    v_sub_f32 v123, v123, v0
    v_sub_f32 v124, v124, v0
    v_sub_f32 v125, v125, v0
    v_sub_f32 v126, v126, v0
    v_sub_f32 v127, v127, v0
    v_exp_f32 v112, v112
    v_exp_f32 v113, v113
    v_exp_f32 v114, v114
    v_cvt_pk_bf16_f32 v60, v112, v113
    v_exp_f32 v115, v115
    v_exp_f32 v116, v116
    v_cvt_pk_bf16_f32 v61, v114, v115
    v_exp_f32 v117, v117
    v_exp_f32 v118, v118
    v_cvt_pk_bf16_f32 v62, v116, v117
    v_exp_f32 v119, v119
    v_exp_f32 v120, v120
    v_cvt_pk_bf16_f32 v63, v118, v119
    v_exp_f32 v121, v121
    v_exp_f32 v122, v122
    v_cvt_pk_bf16_f32 v64, v120, v121
    v_exp_f32 v123, v123
    v_exp_f32 v124, v124
    v_cvt_pk_bf16_f32 v65, v122, v123
    v_exp_f32 v125, v125
    v_exp_f32 v126, v126
    v_cvt_pk_bf16_f32 v66, v124, v125
    v_exp_f32 v127, v127
    s_nop 0
    v_cvt_pk_bf16_f32 v67, v126, v127
    s_waitcnt lgkmcnt(0)
    v_mul_f32 v160, v160, v76
    v_mul_f32 v161, v161, v77
    v_mul_f32 v162, v162, v78
    v_mul_f32 v163, v163, v79
    v_mul_f32 v164, v164, v76
    v_mul_f32 v165, v165, v77
    v_mul_f32 v166, v166, v78
    v_mul_f32 v167, v167, v79
    v_mul_f32 v168, v168, v76
    v_mul_f32 v169, v169, v77
    v_mul_f32 v170, v170, v78
    v_mul_f32 v171, v171, v79
    v_mul_f32 v172, v172, v76
    v_mul_f32 v173, v173, v77
    v_mul_f32 v174, v174, v78
    v_mul_f32 v175, v175, v79
    v_mul_f32 v176, v176, v76
    v_mul_f32 v177, v177, v77
    v_mul_f32 v178, v178, v78
    v_mul_f32 v179, v179, v79
    v_mul_f32 v180, v180, v76
    v_mul_f32 v181, v181, v77
    v_mul_f32 v182, v182, v78
    v_mul_f32 v183, v183, v79
    v_mul_f32 v184, v184, v76
    v_mul_f32 v185, v185, v77
    v_mul_f32 v186, v186, v78
    v_mul_f32 v187, v187, v79
    v_mul_f32 v188, v188, v76
    v_mul_f32 v189, v189, v77
    v_mul_f32 v190, v190, v78
    v_mul_f32 v191, v191, v79
    s_nop 1
    v_smfmac_f32_16x16x64_bf16 v[48:51], v[20:23], v[60:67], v24
    v_mfma_f32_16x16x32_bf16 v[160:163], v[60:63], a[128:131], v[160:163]
    v_mfma_f32_16x16x32_bf16 v[160:163], v[64:67], a[132:135], v[160:163]
    v_mfma_f32_16x16x32_bf16 v[164:167], v[60:63], a[136:139], v[164:167]
    v_mfma_f32_16x16x32_bf16 v[164:167], v[64:67], a[140:143], v[164:167]
    v_mfma_f32_16x16x32_bf16 v[168:171], v[60:63], a[144:147], v[168:171]
    v_mfma_f32_16x16x32_bf16 v[168:171], v[64:67], a[148:151], v[168:171]
    v_mfma_f32_16x16x32_bf16 v[172:175], v[60:63], a[152:155], v[172:175]
    v_mfma_f32_16x16x32_bf16 v[172:175], v[64:67], a[156:159], v[172:175]
    v_mfma_f32_16x16x32_bf16 v[176:179], v[60:63], a[160:163], v[176:179]
    v_mfma_f32_16x16x32_bf16 v[176:179], v[64:67], a[164:167], v[176:179]
    v_mfma_f32_16x16x32_bf16 v[180:183], v[60:63], a[168:171], v[180:183]
    v_mfma_f32_16x16x32_bf16 v[180:183], v[64:67], a[172:175], v[180:183]
    v_mfma_f32_16x16x32_bf16 v[184:187], v[60:63], a[176:179], v[184:187]
    v_mfma_f32_16x16x32_bf16 v[184:187], v[64:67], a[180:183], v[184:187]
    v_mfma_f32_16x16x32_bf16 v[188:191], v[60:63], a[184:187], v[188:191]
    v_mfma_f32_16x16x32_bf16 v[188:191], v[64:67], a[188:191], v[188:191]
    v_mfma_f32_16x16x32_bf16 v[96:99], a[64:67], a[32:35], 0
    v_mfma_f32_16x16x32_bf16 v[96:99], a[68:71], a[36:39], v[96:99]
    v_mfma_f32_16x16x32_bf16 v[96:99], a[72:75], a[40:43], v[96:99]
    v_mfma_f32_16x16x32_bf16 v[96:99], a[76:79], a[44:47], v[96:99]
    v_mfma_f32_16x16x32_bf16 v[100:103], a[92:95], a[44:47], 0
    v_mfma_f32_16x16x32_bf16 v[100:103], a[88:91], a[40:43], v[100:103]
    v_mfma_f32_16x16x32_bf16 v[100:103], a[84:87], a[36:39], v[100:103]
    v_mfma_f32_16x16x32_bf16 v[100:103], a[80:83], a[32:35], v[100:103]
    v_mfma_f32_16x16x32_bf16 v[104:107], a[96:99], a[32:35], 0
    v_mfma_f32_16x16x32_bf16 v[104:107], a[100:103], a[36:39], v[104:107]
    v_mfma_f32_16x16x32_bf16 v[104:107], a[104:107], a[40:43], v[104:107]
    v_mfma_f32_16x16x32_bf16 v[104:107], a[108:111], a[44:47], v[104:107]
    v_mfma_f32_16x16x32_bf16 v[108:111], a[124:127], a[44:47], 0
    v_mfma_f32_16x16x32_bf16 v[108:111], a[120:123], a[40:43], v[108:111]
    v_mfma_f32_16x16x32_bf16 v[108:111], a[116:119], a[36:39], v[108:111]
    v_mfma_f32_16x16x32_bf16 v[108:111], a[112:115], a[32:35], v[108:111]
    s_nop 15
    v_max3_f32 v0, v96, v97, v98
    v_max3_f32 v1, v99, v100, v101
    v_max3_f32 v0, v0, v102, v103
    v_max3_f32 v1, v1, v104, v105
    v_max3_f32 v0, v0, v106, v107
    v_max3_f32 v1, v1, v108, v109
    v_max3_f32 v0, v0, v110, v111
    v_max_f32 v0, v0, v1
    v_mov_b32 v1, v0
    s_nop 1
    v_permlane16_swap_b32 v0, v1
    v_max_f32 v0, v0, v1
    v_mov_b32 v1, v0
    s_nop 1
    v_permlane32_swap_b32 v0, v1
    v_max_f32 v0, v0, v1
    v_max_f32 v0, v0, v70
    v_sub_f32 v1, v70, v0
    v_exp_f32 v1, v1
    v_mov_b32 v70, v0
    ds_bpermute_b32 v76, v31, v1 offset:0
    ds_bpermute_b32 v77, v31, v1 offset:4
    ds_bpermute_b32 v78, v31, v1 offset:8
    ds_bpermute_b32 v79, v31, v1 offset:12
    v_mul_f32 v84, v84, v1
    v_mul_f32 v85, v85, v1
    v_sub_f32 v96, v96, v0
    v_sub_f32 v97, v97, v0
    v_sub_f32 v98, v98, v0
    v_sub_f32 v99, v99, v0
    v_sub_f32 v100, v100, v0
    v_sub_f32 v101, v101, v0
    v_sub_f32 v102, v102, v0
    v_sub_f32 v103, v103, v0
    v_sub_f32 v104, v104, v0
    v_sub_f32 v105, v105, v0
    v_sub_f32 v106, v106, v0
    v_sub_f32 v107, v107, v0
    v_sub_f32 v108, v108, v0
    v_sub_f32 v109, v109, v0
    v_sub_f32 v110, v110, v0
    v_sub_f32 v111, v111, v0
    v_exp_f32 v96, v96
    v_exp_f32 v97, v97
    v_exp_f32 v98, v98
    v_cvt_pk_bf16_f32 v52, v96, v97
    v_exp_f32 v99, v99
    v_exp_f32 v100, v100
    v_cvt_pk_bf16_f32 v53, v98, v99
    v_exp_f32 v101, v101
    v_exp_f32 v102, v102
    v_cvt_pk_bf16_f32 v54, v100, v101
    v_exp_f32 v103, v103
    v_exp_f32 v104, v104
    v_cvt_pk_bf16_f32 v55, v102, v103
    v_exp_f32 v105, v105
    v_exp_f32 v106, v106
    v_cvt_pk_bf16_f32 v56, v104, v105
    v_exp_f32 v107, v107
    v_exp_f32 v108, v108
    v_cvt_pk_bf16_f32 v57, v106, v107
    v_exp_f32 v109, v109
    v_exp_f32 v110, v110
    v_cvt_pk_bf16_f32 v58, v108, v109
    v_exp_f32 v111, v111
    s_nop 0
    v_cvt_pk_bf16_f32 v59, v110, v111
    s_waitcnt lgkmcnt(0)
    v_mul_f32 v192, v192, v76
    v_mul_f32 v193, v193, v77
    v_mul_f32 v194, v194, v78
    v_mul_f32 v195, v195, v79
    v_mul_f32 v196, v196, v76
    v_mul_f32 v197, v197, v77
    v_mul_f32 v198, v198, v78
    v_mul_f32 v199, v199, v79
    v_mul_f32 v200, v200, v76
    v_mul_f32 v201, v201, v77
    v_mul_f32 v202, v202, v78
    v_mul_f32 v203, v203, v79
    v_mul_f32 v204, v204, v76
    v_mul_f32 v205, v205, v77
    v_mul_f32 v206, v206, v78
    v_mul_f32 v207, v207, v79
    v_mul_f32 v208, v208, v76
    v_mul_f32 v209, v209, v77
    v_mul_f32 v210, v210, v78
    v_mul_f32 v211, v211, v79
    v_mul_f32 v212, v212, v76
    v_mul_f32 v213, v213, v77
    v_mul_f32 v214, v214, v78
    v_mul_f32 v215, v215, v79
    v_mul_f32 v216, v216, v76
    v_mul_f32 v217, v217, v77
    v_mul_f32 v218, v218, v78
    v_mul_f32 v219, v219, v79
    v_mul_f32 v220, v220, v76
    v_mul_f32 v221, v221, v77
    v_mul_f32 v222, v222, v78
    v_mul_f32 v223, v223, v79
    s_nop 1
    v_smfmac_f32_16x16x64_bf16 v[84:87], v[20:23], v[52:59], v24
    v_mfma_f32_16x16x32_bf16 v[192:195], v[52:55], a[128:131], v[192:195]
    v_mfma_f32_16x16x32_bf16 v[192:195], v[56:59], a[132:135], v[192:195]
    v_mfma_f32_16x16x32_bf16 v[196:199], v[52:55], a[136:139], v[196:199]
    v_mfma_f32_16x16x32_bf16 v[196:199], v[56:59], a[140:143], v[196:199]
    v_mfma_f32_16x16x32_bf16 v[200:203], v[52:55], a[144:147], v[200:203]
    v_mfma_f32_16x16x32_bf16 v[200:203], v[56:59], a[148:151], v[200:203]
    v_mfma_f32_16x16x32_bf16 v[204:207], v[52:55], a[152:155], v[204:207]
    v_mfma_f32_16x16x32_bf16 v[204:207], v[56:59], a[156:159], v[204:207]
    v_mfma_f32_16x16x32_bf16 v[208:211], v[52:55], a[160:163], v[208:211]
    v_mfma_f32_16x16x32_bf16 v[208:211], v[56:59], a[164:167], v[208:211]
    v_mfma_f32_16x16x32_bf16 v[212:215], v[52:55], a[168:171], v[212:215]
    v_mfma_f32_16x16x32_bf16 v[212:215], v[56:59], a[172:175], v[212:215]
    v_mfma_f32_16x16x32_bf16 v[216:219], v[52:55], a[176:179], v[216:219]
    v_mfma_f32_16x16x32_bf16 v[216:219], v[56:59], a[180:183], v[216:219]
    v_mfma_f32_16x16x32_bf16 v[220:223], v[52:55], a[184:187], v[220:223]
    v_mfma_f32_16x16x32_bf16 v[220:223], v[56:59], a[188:191], v[220:223]
    v_mfma_f32_16x16x32_bf16 v[112:115], a[64:67], a[48:51], 0
    v_mfma_f32_16x16x32_bf16 v[112:115], a[68:71], a[52:55], v[112:115]
    v_mfma_f32_16x16x32_bf16 v[112:115], a[72:75], a[56:59], v[112:115]
    v_mfma_f32_16x16x32_bf16 v[112:115], a[76:79], a[60:63], v[112:115]
    v_mfma_f32_16x16x32_bf16 v[116:119], a[92:95], a[60:63], 0
    v_mfma_f32_16x16x32_bf16 v[116:119], a[88:91], a[56:59], v[116:119]
    v_mfma_f32_16x16x32_bf16 v[116:119], a[84:87], a[52:55], v[116:119]
    v_mfma_f32_16x16x32_bf16 v[116:119], a[80:83], a[48:51], v[116:119]
    v_mfma_f32_16x16x32_bf16 v[120:123], a[96:99], a[48:51], 0
    v_mfma_f32_16x16x32_bf16 v[120:123], a[100:103], a[52:55], v[120:123]
    v_mfma_f32_16x16x32_bf16 v[120:123], a[104:107], a[56:59], v[120:123]
    v_mfma_f32_16x16x32_bf16 v[120:123], a[108:111], a[60:63], v[120:123]
    v_mfma_f32_16x16x32_bf16 v[124:127], a[124:127], a[60:63], 0
    v_mfma_f32_16x16x32_bf16 v[124:127], a[120:123], a[56:59], v[124:127]
    v_mfma_f32_16x16x32_bf16 v[124:127], a[116:119], a[52:55], v[124:127]
    v_mfma_f32_16x16x32_bf16 v[124:127], a[112:115], a[48:51], v[124:127]
    s_nop 15
    v_max3_f32 v0, v112, v113, v114
    v_max3_f32 v1, v115, v116, v117
    v_max3_f32 v0, v0, v118, v119
    v_max3_f32 v1, v1, v120, v121
    v_max3_f32 v0, v0, v122, v123
    v_max3_f32 v1, v1, v124, v125
    v_max3_f32 v0, v0, v126, v127
    v_max_f32 v0, v0, v1
    v_mov_b32 v1, v0
    s_nop 1
    v_permlane16_swap_b32 v0, v1
    v_max_f32 v0, v0, v1
    v_mov_b32 v1, v0
    s_nop 1
    v_permlane32_swap_b32 v0, v1
    v_max_f32 v0, v0, v1
    v_max_f32 v0, v0, v71
    v_sub_f32 v1, v71, v0
    v_exp_f32 v1, v1
    v_mov_b32 v71, v0
    ds_bpermute_b32 v76, v31, v1 offset:0
    ds_bpermute_b32 v77, v31, v1 offset:4
    ds_bpermute_b32 v78, v31, v1 offset:8
    ds_bpermute_b32 v79, v31, v1 offset:12
    v_mul_f32 v88, v88, v1
    v_mul_f32 v89, v89, v1
    v_sub_f32 v112, v112, v0
    v_sub_f32 v113, v113, v0
    v_sub_f32 v114, v114, v0
    v_sub_f32 v115, v115, v0
    v_sub_f32 v116, v116, v0
    v_sub_f32 v117, v117, v0
    v_sub_f32 v118, v118, v0
    v_sub_f32 v119, v119, v0
    v_sub_f32 v120, v120, v0
    v_sub_f32 v121, v121, v0
    v_sub_f32 v122, v122, v0
    v_sub_f32 v123, v123, v0
    v_sub_f32 v124, v124, v0
    v_sub_f32 v125, v125, v0
    v_sub_f32 v126, v126, v0
    v_sub_f32 v127, v127, v0
    v_exp_f32 v112, v112
    v_exp_f32 v113, v113
    v_exp_f32 v114, v114
    v_cvt_pk_bf16_f32 v60, v112, v113
    v_exp_f32 v115, v115
    v_exp_f32 v116, v116
    v_cvt_pk_bf16_f32 v61, v114, v115
    v_exp_f32 v117, v117
    v_exp_f32 v118, v118
    v_cvt_pk_bf16_f32 v62, v116, v117
    v_exp_f32 v119, v119
    v_exp_f32 v120, v120
    v_cvt_pk_bf16_f32 v63, v118, v119
    v_exp_f32 v121, v121
    v_exp_f32 v122, v122
    v_cvt_pk_bf16_f32 v64, v120, v121
    v_exp_f32 v123, v123
    v_exp_f32 v124, v124
    v_cvt_pk_bf16_f32 v65, v122, v123
    v_exp_f32 v125, v125
    v_exp_f32 v126, v126
    v_cvt_pk_bf16_f32 v66, v124, v125
    v_exp_f32 v127, v127
    s_nop 0
    v_cvt_pk_bf16_f32 v67, v126, v127
    s_waitcnt lgkmcnt(0)
    v_mul_f32 v224, v224, v76
    v_mul_f32 v225, v225, v77
    v_mul_f32 v226, v226, v78
    v_mul_f32 v227, v227, v79
    v_mul_f32 v228, v228, v76
    v_mul_f32 v229, v229, v77
    v_mul_f32 v230, v230, v78
    v_mul_f32 v231, v231, v79
    v_mul_f32 v232, v232, v76
    v_mul_f32 v233, v233, v77
    v_mul_f32 v234, v234, v78
    v_mul_f32 v235, v235, v79
    v_mul_f32 v236, v236, v76
    v_mul_f32 v237, v237, v77
    v_mul_f32 v238, v238, v78
    v_mul_f32 v239, v239, v79
    v_mul_f32 v240, v240, v76
    v_mul_f32 v241, v241, v77
    v_mul_f32 v242, v242, v78
    v_mul_f32 v243, v243, v79
    v_mul_f32 v244, v244, v76
    v_mul_f32 v245, v245, v77
    v_mul_f32 v246, v246, v78
    v_mul_f32 v247, v247, v79
    v_mul_f32 v248, v248, v76
    v_mul_f32 v249, v249, v77
    v_mul_f32 v250, v250, v78
    v_mul_f32 v251, v251, v79
    v_mul_f32 v252, v252, v76
    v_mul_f32 v253, v253, v77
    v_mul_f32 v254, v254, v78
    v_mul_f32 v255, v255, v79
    s_nop 1
    v_smfmac_f32_16x16x64_bf16 v[88:91], v[20:23], v[60:67], v24
    v_mfma_f32_16x16x32_bf16 v[224:227], v[60:63], a[128:131], v[224:227]
    v_mfma_f32_16x16x32_bf16 v[224:227], v[64:67], a[132:135], v[224:227]
    v_mfma_f32_16x16x32_bf16 v[228:231], v[60:63], a[136:139], v[228:231]
    v_mfma_f32_16x16x32_bf16 v[228:231], v[64:67], a[140:143], v[228:231]
    v_mfma_f32_16x16x32_bf16 v[232:235], v[60:63], a[144:147], v[232:235]
    v_mfma_f32_16x16x32_bf16 v[232:235], v[64:67], a[148:151], v[232:235]
    v_mfma_f32_16x16x32_bf16 v[236:239], v[60:63], a[152:155], v[236:239]
    v_mfma_f32_16x16x32_bf16 v[236:239], v[64:67], a[156:159], v[236:239]
    v_mfma_f32_16x16x32_bf16 v[240:243], v[60:63], a[160:163], v[240:243]
    v_mfma_f32_16x16x32_bf16 v[240:243], v[64:67], a[164:167], v[240:243]
    v_mfma_f32_16x16x32_bf16 v[244:247], v[60:63], a[168:171], v[244:247]
    v_mfma_f32_16x16x32_bf16 v[244:247], v[64:67], a[172:175], v[244:247]
    v_mfma_f32_16x16x32_bf16 v[248:251], v[60:63], a[176:179], v[248:251]
    v_mfma_f32_16x16x32_bf16 v[248:251], v[64:67], a[180:183], v[248:251]
    v_mfma_f32_16x16x32_bf16 v[252:255], v[60:63], a[184:187], v[252:255]
    v_mfma_f32_16x16x32_bf16 v[252:255], v[64:67], a[188:191], v[252:255]
    s_nop 15
    s_add_u32 s33, s33, 0x4000
    s_cmp_lt_u32 s33, 0x80000
    s_cbranch_scc1 L_slow_loop
    v_add_f32 v92, v44, v45
    v_rcp_f32 v92, v92
    s_nop 0
    ds_bpermute_b32 v44, v31, v92 offset:0
    ds_bpermute_b32 v45, v31, v92 offset:4
    ds_bpermute_b32 v46, v31, v92 offset:8
    ds_bpermute_b32 v47, v31, v92 offset:12
    s_waitcnt lgkmcnt(0)
    v_pk_mul_f32 v[128:129], v[128:129], v[44:45]
    v_pk_mul_f32 v[132:133], v[132:133], v[44:45]
    v_pk_mul_f32 v[136:137], v[136:137], v[44:45]
    v_pk_mul_f32 v[140:141], v[140:141], v[44:45]
    v_pk_mul_f32 v[144:145], v[144:145], v[44:45]
    v_pk_mul_f32 v[148:149], v[148:149], v[44:45]
    v_pk_mul_f32 v[152:153], v[152:153], v[44:45]
    v_pk_mul_f32 v[156:157], v[156:157], v[44:45]
    v_pk_mul_f32 v[130:131], v[130:131], v[46:47]
    v_pk_mul_f32 v[134:135], v[134:135], v[46:47]
    v_pk_mul_f32 v[138:139], v[138:139], v[46:47]
    v_pk_mul_f32 v[142:143], v[142:143], v[46:47]
    v_pk_mul_f32 v[146:147], v[146:147], v[46:47]
    v_pk_mul_f32 v[150:151], v[150:151], v[46:47]
    v_pk_mul_f32 v[154:155], v[154:155], v[46:47]
    v_pk_mul_f32 v[158:159], v[158:159], v[46:47]
    v_cvt_pk_bf16_f32 v0, v128, v132
    v_cvt_pk_bf16_f32 v1, v136, v140
    v_cvt_pk_bf16_f32 v2, v144, v148
    v_cvt_pk_bf16_f32 v3, v152, v156
    ds_write_b128 v16, v[0:3] offset:0
    v_cvt_pk_bf16_f32 v4, v129, v133
    v_cvt_pk_bf16_f32 v5, v137, v141
    v_cvt_pk_bf16_f32 v6, v145, v149
    v_cvt_pk_bf16_f32 v7, v153, v157
    ds_write_b128 v17, v[4:7] offset:1024
    v_cvt_pk_bf16_f32 v8, v130, v134
    v_cvt_pk_bf16_f32 v9, v138, v142
    v_cvt_pk_bf16_f32 v10, v146, v150
    v_cvt_pk_bf16_f32 v11, v154, v158
    ds_write_b128 v16, v[8:11] offset:8192
    v_cvt_pk_bf16_f32 v12, v131, v135
    v_cvt_pk_bf16_f32 v13, v139, v143
    v_cvt_pk_bf16_f32 v14, v147, v151
    v_cvt_pk_bf16_f32 v15, v155, v159
    ds_write_b128 v17, v[12:15] offset:9216
    ds_read_b64_tr_b16 v[128:129], v18 offset:0
    ds_read_b64_tr_b16 v[130:131], v19 offset:0
    ds_read_b64_tr_b16 v[132:133], v18 offset:256
    ds_read_b64_tr_b16 v[134:135], v19 offset:256
    ds_read_b64_tr_b16 v[136:137], v18 offset:512
    ds_read_b64_tr_b16 v[138:139], v19 offset:512
    ds_read_b64_tr_b16 v[140:141], v18 offset:768
    ds_read_b64_tr_b16 v[142:143], v19 offset:768
    s_waitcnt lgkmcnt(0)
    buffer_store_dwordx4 v[128:131], v30, s[28:31], 0 offen sc1
    buffer_store_dwordx4 v[132:135], v30, s[28:31], 0 offen offset:1024 sc1
    buffer_store_dwordx4 v[136:139], v30, s[28:31], 0 offen offset:2048 sc1
    buffer_store_dwordx4 v[140:143], v30, s[28:31], 0 offen offset:3072 sc1
    v_add_f32 v92, v48, v49
    v_rcp_f32 v92, v92
    s_nop 0
    ds_bpermute_b32 v48, v31, v92 offset:0
    ds_bpermute_b32 v49, v31, v92 offset:4
    ds_bpermute_b32 v50, v31, v92 offset:8
    ds_bpermute_b32 v51, v31, v92 offset:12
    s_waitcnt lgkmcnt(0)
    v_pk_mul_f32 v[160:161], v[160:161], v[48:49]
    v_pk_mul_f32 v[164:165], v[164:165], v[48:49]
    v_pk_mul_f32 v[168:169], v[168:169], v[48:49]
    v_pk_mul_f32 v[172:173], v[172:173], v[48:49]
    v_pk_mul_f32 v[176:177], v[176:177], v[48:49]
    v_pk_mul_f32 v[180:181], v[180:181], v[48:49]
    v_pk_mul_f32 v[184:185], v[184:185], v[48:49]
    v_pk_mul_f32 v[188:189], v[188:189], v[48:49]
    v_pk_mul_f32 v[162:163], v[162:163], v[50:51]
    v_pk_mul_f32 v[166:167], v[166:167], v[50:51]
    v_pk_mul_f32 v[170:171], v[170:171], v[50:51]
    v_pk_mul_f32 v[174:175], v[174:175], v[50:51]
    v_pk_mul_f32 v[178:179], v[178:179], v[50:51]
    v_pk_mul_f32 v[182:183], v[182:183], v[50:51]
    v_pk_mul_f32 v[186:187], v[186:187], v[50:51]
    v_pk_mul_f32 v[190:191], v[190:191], v[50:51]
    v_cvt_pk_bf16_f32 v0, v160, v164
    v_cvt_pk_bf16_f32 v1, v168, v172
    v_cvt_pk_bf16_f32 v2, v176, v180
    v_cvt_pk_bf16_f32 v3, v184, v188
    ds_write_b128 v16, v[0:3] offset:49152
    v_cvt_pk_bf16_f32 v4, v161, v165
    v_cvt_pk_bf16_f32 v5, v169, v173
    v_cvt_pk_bf16_f32 v6, v177, v181
    v_cvt_pk_bf16_f32 v7, v185, v189
    ds_write_b128 v17, v[4:7] offset:50176
    v_cvt_pk_bf16_f32 v8, v162, v166
    v_cvt_pk_bf16_f32 v9, v170, v174
    v_cvt_pk_bf16_f32 v10, v178, v182
    v_cvt_pk_bf16_f32 v11, v186, v190
    ds_write_b128 v16, v[8:11] offset:57344
    v_cvt_pk_bf16_f32 v12, v163, v167
    v_cvt_pk_bf16_f32 v13, v171, v175
    v_cvt_pk_bf16_f32 v14, v179, v183
    v_cvt_pk_bf16_f32 v15, v187, v191
    ds_write_b128 v17, v[12:15] offset:58368
    ds_read_b64_tr_b16 v[160:161], v18 offset:49152
    ds_read_b64_tr_b16 v[162:163], v19 offset:49152
    ds_read_b64_tr_b16 v[164:165], v18 offset:49408
    ds_read_b64_tr_b16 v[166:167], v19 offset:49408
    ds_read_b64_tr_b16 v[168:169], v18 offset:49664
    ds_read_b64_tr_b16 v[170:171], v19 offset:49664
    ds_read_b64_tr_b16 v[172:173], v18 offset:49920
    ds_read_b64_tr_b16 v[174:175], v19 offset:49920
    s_waitcnt lgkmcnt(0)
    buffer_store_dwordx4 v[160:163], v30, s[28:31], s56 offen sc1
    buffer_store_dwordx4 v[164:167], v30, s[28:31], s56 offen offset:1024 sc1
    buffer_store_dwordx4 v[168:171], v30, s[28:31], s56 offen offset:2048 sc1
    buffer_store_dwordx4 v[172:175], v30, s[28:31], s56 offen offset:3072 sc1
    v_add_f32 v92, v84, v85
    v_rcp_f32 v92, v92
    s_nop 0
    ds_bpermute_b32 v84, v31, v92 offset:0
    ds_bpermute_b32 v85, v31, v92 offset:4
    ds_bpermute_b32 v86, v31, v92 offset:8
    ds_bpermute_b32 v87, v31, v92 offset:12
    s_waitcnt lgkmcnt(0)
    v_pk_mul_f32 v[192:193], v[192:193], v[84:85]
    v_pk_mul_f32 v[196:197], v[196:197], v[84:85]
    v_pk_mul_f32 v[200:201], v[200:201], v[84:85]
    v_pk_mul_f32 v[204:205], v[204:205], v[84:85]
    v_pk_mul_f32 v[208:209], v[208:209], v[84:85]
    v_pk_mul_f32 v[212:213], v[212:213], v[84:85]
    v_pk_mul_f32 v[216:217], v[216:217], v[84:85]
    v_pk_mul_f32 v[220:221], v[220:221], v[84:85]
    v_pk_mul_f32 v[194:195], v[194:195], v[86:87]
    v_pk_mul_f32 v[198:199], v[198:199], v[86:87]
    v_pk_mul_f32 v[202:203], v[202:203], v[86:87]
    v_pk_mul_f32 v[206:207], v[206:207], v[86:87]
    v_pk_mul_f32 v[210:211], v[210:211], v[86:87]
    v_pk_mul_f32 v[214:215], v[214:215], v[86:87]
    v_pk_mul_f32 v[218:219], v[218:219], v[86:87]
    v_pk_mul_f32 v[222:223], v[222:223], v[86:87]
    v_cvt_pk_bf16_f32 v0, v192, v196
    v_cvt_pk_bf16_f32 v1, v200, v204
    v_cvt_pk_bf16_f32 v2, v208, v212
    v_cvt_pk_bf16_f32 v3, v216, v220
    ds_write_b128 v16, v[0:3] offset:0
    v_cvt_pk_bf16_f32 v4, v193, v197
    v_cvt_pk_bf16_f32 v5, v201, v205
    v_cvt_pk_bf16_f32 v6, v209, v213
    v_cvt_pk_bf16_f32 v7, v217, v221
    ds_write_b128 v17, v[4:7] offset:1024
    v_cvt_pk_bf16_f32 v8, v194, v198
    v_cvt_pk_bf16_f32 v9, v202, v206
    v_cvt_pk_bf16_f32 v10, v210, v214
    v_cvt_pk_bf16_f32 v11, v218, v222
    ds_write_b128 v16, v[8:11] offset:8192
    v_cvt_pk_bf16_f32 v12, v195, v199
    v_cvt_pk_bf16_f32 v13, v203, v207
    v_cvt_pk_bf16_f32 v14, v211, v215
    v_cvt_pk_bf16_f32 v15, v219, v223
    ds_write_b128 v17, v[12:15] offset:9216
    ds_read_b64_tr_b16 v[192:193], v18 offset:0
    ds_read_b64_tr_b16 v[194:195], v19 offset:0
    ds_read_b64_tr_b16 v[196:197], v18 offset:256
    ds_read_b64_tr_b16 v[198:199], v19 offset:256
    ds_read_b64_tr_b16 v[200:201], v18 offset:512
    ds_read_b64_tr_b16 v[202:203], v19 offset:512
    ds_read_b64_tr_b16 v[204:205], v18 offset:768
    ds_read_b64_tr_b16 v[206:207], v19 offset:768
    s_waitcnt lgkmcnt(0)
    buffer_store_dwordx4 v[192:195], v30, s[28:31], s57 offen sc1
    buffer_store_dwordx4 v[196:199], v30, s[28:31], s57 offen offset:1024 sc1
    buffer_store_dwordx4 v[200:203], v30, s[28:31], s57 offen offset:2048 sc1
    buffer_store_dwordx4 v[204:207], v30, s[28:31], s57 offen offset:3072 sc1
    v_add_f32 v92, v88, v89
    v_rcp_f32 v92, v92
    s_nop 0
    ds_bpermute_b32 v88, v31, v92 offset:0
    ds_bpermute_b32 v89, v31, v92 offset:4
    ds_bpermute_b32 v90, v31, v92 offset:8
    ds_bpermute_b32 v91, v31, v92 offset:12
    s_waitcnt lgkmcnt(0)
    v_pk_mul_f32 v[224:225], v[224:225], v[88:89]
    v_pk_mul_f32 v[228:229], v[228:229], v[88:89]
    v_pk_mul_f32 v[232:233], v[232:233], v[88:89]
    v_pk_mul_f32 v[236:237], v[236:237], v[88:89]
    v_pk_mul_f32 v[240:241], v[240:241], v[88:89]
    v_pk_mul_f32 v[244:245], v[244:245], v[88:89]
    v_pk_mul_f32 v[248:249], v[248:249], v[88:89]
    v_pk_mul_f32 v[252:253], v[252:253], v[88:89]
    v_pk_mul_f32 v[226:227], v[226:227], v[90:91]
    v_pk_mul_f32 v[230:231], v[230:231], v[90:91]
    v_pk_mul_f32 v[234:235], v[234:235], v[90:91]
    v_pk_mul_f32 v[238:239], v[238:239], v[90:91]
    v_pk_mul_f32 v[242:243], v[242:243], v[90:91]
    v_pk_mul_f32 v[246:247], v[246:247], v[90:91]
    v_pk_mul_f32 v[250:251], v[250:251], v[90:91]
    v_pk_mul_f32 v[254:255], v[254:255], v[90:91]
    v_cvt_pk_bf16_f32 v0, v224, v228
    v_cvt_pk_bf16_f32 v1, v232, v236
    v_cvt_pk_bf16_f32 v2, v240, v244
    v_cvt_pk_bf16_f32 v3, v248, v252
    ds_write_b128 v16, v[0:3] offset:49152
    v_cvt_pk_bf16_f32 v4, v225, v229
    v_cvt_pk_bf16_f32 v5, v233, v237
    v_cvt_pk_bf16_f32 v6, v241, v245
    v_cvt_pk_bf16_f32 v7, v249, v253
    ds_write_b128 v17, v[4:7] offset:50176
    v_cvt_pk_bf16_f32 v8, v226, v230
    v_cvt_pk_bf16_f32 v9, v234, v238
    v_cvt_pk_bf16_f32 v10, v242, v246
    v_cvt_pk_bf16_f32 v11, v250, v254
    ds_write_b128 v16, v[8:11] offset:57344
    v_cvt_pk_bf16_f32 v12, v227, v231
    v_cvt_pk_bf16_f32 v13, v235, v239
    v_cvt_pk_bf16_f32 v14, v243, v247
    v_cvt_pk_bf16_f32 v15, v251, v255
    ds_write_b128 v17, v[12:15] offset:58368
    ds_read_b64_tr_b16 v[224:225], v18 offset:49152
    ds_read_b64_tr_b16 v[226:227], v19 offset:49152
    ds_read_b64_tr_b16 v[228:229], v18 offset:49408
    ds_read_b64_tr_b16 v[230:231], v19 offset:49408
    ds_read_b64_tr_b16 v[232:233], v18 offset:49664
    ds_read_b64_tr_b16 v[234:235], v19 offset:49664
    ds_read_b64_tr_b16 v[236:237], v18 offset:49920
    ds_read_b64_tr_b16 v[238:239], v19 offset:49920
    s_waitcnt lgkmcnt(0)
    buffer_store_dwordx4 v[224:227], v30, s[28:31], s58 offen sc1
    buffer_store_dwordx4 v[228:231], v30, s[28:31], s58 offen offset:1024 sc1
    buffer_store_dwordx4 v[232:235], v30, s[28:31], s58 offen offset:2048 sc1
    buffer_store_dwordx4 v[236:239], v30, s[28:31], s58 offen offset:3072 sc1
    s_endpgm
.section .rodata,"a"
.p2align 6
.amdhsa_kernel standalone__mha_softmax__near_ridge_kernel
  .amdhsa_next_free_vgpr 512
  .amdhsa_next_free_sgpr 102
  .amdhsa_accum_offset 256
  .amdhsa_group_segment_fixed_size 0
  .amdhsa_kernarg_size 48
  .amdhsa_user_sgpr_count 2
  .amdhsa_user_sgpr_kernarg_segment_ptr 1
  .amdhsa_system_sgpr_workgroup_id_x 1
  .amdhsa_float_denorm_mode_32 3
.end_amdhsa_kernel
```
